```python
import torch

def _softmax(x, axis=-1):
    return torch.softmax(x, dim=axis)
def _gelu(x):
    return torch.nn.functional.gelu(x, approximate="tanh")
def _silu(x):
    return torch.nn.functional.silu(x)
def _sigmoid(x):
    return torch.sigmoid(x)
def _layernorm(x, axis=-1, eps=1e-5):
    m = x.mean(dim=axis, keepdim=True)
    v = x.var(dim=axis, keepdim=True, unbiased=False)
    return (x - m) / torch.sqrt(v + eps)
def _scatter_add(tgt, idx, src, axis=0):
    return tgt.clone().index_add_(axis, idx, src)
def _segment_sum(src, seg, n):
    out = torch.zeros((n,) + src.shape[1:], dtype=src.dtype)
    return out.index_add_(0, seg, src)
def _pad(x, pw):
    flat = tuple(v for pair in reversed(pw) for v in pair)
    return torch.nn.functional.pad(x, flat)

kernel_name = 'parallel_sum__linear_kernel_hedgehog__glu_gated_reglu__prompt'

def setup_inputs():

    _w = (lambda a: (lambda t: t.to(torch.bfloat16) if t.is_floating_point() else t)(torch.as_tensor(a)))
    def _A_setup():
        B, S, D, H = 1, 2048, 512, 32
        Dh = D // H
        return {
            "x": _w((lambda *s: torch.randn(*s, dtype=torch.bfloat16) * 0.05)(B, S, D)),
            "wqkv": _w((lambda *s: torch.randn(*s, dtype=torch.bfloat16) * 0.2)(D, 3 * D)),
            "w_phi": _w((lambda *s: torch.randn(*s, dtype=torch.bfloat16) * 0.2)(H, Dh, Dh) * (Dh ** -0.5)),
            "wo": _w((lambda *s: torch.randn(*s, dtype=torch.bfloat16) * 0.05)(D, D)),
        }
    _A_in = _A_setup()

    def _B_setup():
        B, S, D, F = 1, 2048, 512, 1376
        return {
            "x": _w((lambda *s: torch.randn(*s, dtype=torch.bfloat16) * 0.05)(B, S, D)),
            "W_gate": _w((lambda *s: torch.randn(*s, dtype=torch.bfloat16) * 0.4)(D, F) * (2.0 / D) ** 0.5),
            "W_up": _w((lambda *s: torch.randn(*s, dtype=torch.bfloat16) * 0.4)(D, F) * (2.0 / D) ** 0.5),
            "W_down": _w((lambda *s: torch.randn(*s, dtype=torch.bfloat16) * 0.4)(F, D) * (1.0 / F) ** 0.5),
        }
    _B_in = _B_setup()

    return {
        "A_x": _A_in["x"],
        "A_wqkv": _A_in["wqkv"],
        "A_w_phi": _A_in["w_phi"],
        "A_wo": _A_in["wo"],
        "B_x": _B_in["x"],
        "B_W_gate": _B_in["W_gate"],
        "B_W_up": _B_in["W_up"],
        "B_W_down": _B_in["W_down"],
    }

def reference(A_x, A_wqkv, A_w_phi, A_wo, B_x, B_W_gate, B_W_up, B_W_down):
    def _A_ref(x, wqkv, w_phi, wo):
        B, S, D = x.shape
        H = 32; Dh = D // H
        qkv = (lambda x, *d: x.permute(*d))((x @ wqkv).reshape(B, S, 3, H, Dh), 2, 0, 3, 1, 4)
        q, k, v = qkv[0], qkv[1], qkv[2]
        pq = torch.einsum("bhsd,hdf->bhsf", q, w_phi)
        pk = torch.einsum("bhsd,hdf->bhsf", k, w_phi)
        phi_q = torch.concatenate([_softmax(pq, axis=-1), _softmax(-pq, axis=-1)], axis=-1)
        phi_k = torch.concatenate([_softmax(pk, axis=-1), _softmax(-pk, axis=-1)], axis=-1)
        kv = torch.einsum("bhsf,bhsd->bhfd", phi_k, v)
        z  = torch.einsum("bhsf->bhf", phi_k)
        num = torch.einsum("bhqf,bhfd->bhqd", phi_q, kv)
        den = torch.einsum("bhqf,bhf->bhq", phi_q, z)[..., None] + 1e-6
        o = num / den
        return (lambda x, *d: x.permute(*d))(o, 0, 2, 1, 3).reshape(B, S, D) @ wo

    def _B_ref(x, W_gate, W_up, W_down):
        gate = torch.einsum("bsd,df->bsf", x, W_gate)
        up = torch.einsum("bsd,df->bsf", x, W_up)
        gate = gate * (lambda x, dt: x.to(dt))(gate > 0, gate.dtype)
        h = gate * up
        return torch.einsum("bsf,fd->bsd", h, W_down)

    x = A_x
    xn = _layernorm(x, axis=-1)
    return x + _A_ref(xn, A_wqkv, A_w_phi, A_wo) + _B_ref(xn, B_W_gate, B_W_up, B_W_down)
```

```asm
; @launch grid=(256,1,1) block=(256,1,1) lds=163840
.amdgcn_target "amdgcn-amd-amdhsa--gfx950"
.text
.globl parallel_sum__linear_kernel_hedgehog__glu_gated_reglu__prompt_kernel
.p2align 8
.type parallel_sum__linear_kernel_hedgehog__glu_gated_reglu__prompt_kernel,@function
parallel_sum__linear_kernel_hedgehog__glu_gated_reglu__prompt_kernel:
    s_cmp_ge_u32 s2, 256
    s_cbranch_scc1 L_end
    s_load_dwordx2 s[8:9], s[0:1], 0
    s_load_dwordx2 s[16:17], s[0:1], 16
    s_load_dwordx2 s[12:13], s[0:1], 8
    s_load_dwordx2 s[4:5], s[0:1], 40
    s_load_dwordx2 s[6:7], s[0:1], 48
    s_load_dwordx2 s[32:33], s[0:1], 80
    s_load_dwordx2 s[24:25], s[0:1], 56
    s_load_dwordx2 s[20:21], s[0:1], 24
    s_load_dwordx2 s[28:29], s[0:1], 64
    s_mov_b32 s10, 2097152
    s_mov_b32 s11, 0x20000
    s_mov_b32 s18, 16384
    s_mov_b32 s19, 0x20000
    s_mov_b32 s14, 1572864
    s_mov_b32 s15, 0x20000
    s_mov_b32 s38, 1409024
    s_mov_b32 s39, 0x20000
    s_mov_b32 s34, 16777216
    s_mov_b32 s35, 0x20000
    s_mov_b32 s26, 1409024
    s_mov_b32 s27, 0x20000
    s_mov_b32 s22, 524288
    s_mov_b32 s23, 0x20000
    s_mov_b32 s30, 2097152
    s_mov_b32 s31, 0x20000
    v_and_b32 v1, 63, v0
    v_lshrrev_b32 v18, 6, v0
    v_lshlrev_b32 v2, 4, v1
    v_readfirstlane_b32 s68, v18
    s_and_b32 s72, s2, 7
    s_lshr_b32 s73, s2, 3
    s_and_b32 s74, s72, 1
    s_lshl_b32 s74, s74, 3
    s_and_b32 s75, s73, 7
    s_add_u32 s69, s74, s75
    s_lshr_b32 s74, s72, 1
    s_lshl_b32 s74, s74, 2
    s_lshr_b32 s75, s73, 3
    s_add_u32 s70, s74, s75
    s_lshl_b32 s87, s72, 2
    s_and_b32 s75, s73, 3
    s_add_u32 s87, s87, s75
    s_lshr_b32 s88, s73, 2
    s_lshl_b32 s40, s70, 1
    s_add_u32 s40, s40, s69
    s_and_b32 s40, s40, 7
    v_lshrrev_b32 v18, 3, v1
    v_lshrrev_b32 v19, 4, v1
    v_and_b32 v20, 7, v1
    v_xor_b32 v19, v19, v20
    v_lshlrev_b32 v18, 10, v18
    v_lshl_add_u32 v112, v19, 4, v18
    v_xor_b32 v18, 64, v112
    v_add_u32 v113, 7168, v18
    v_add_u32 v114, 14336, v112
    v_add_u32 v115, 21504, v18
    s_lshl_b32 s79, s69, 17
    s_lshl_b32 s81, s68, 15
    s_add_u32 s79, s79, s81
    s_lshl_b32 s81, s68, 12
    s_add_u32 s81, s81, 32768
    s_waitcnt lgkmcnt(0)
    s_lshl_b32 s83, s70, 10
    s_mov_b32 m0, 0
    s_nop 0
    buffer_load_dwordx4 v2, s[16:19], s83 offen lds
    s_add_u32 s72, s40, 0
    s_and_b32 s72, s72, 7
    s_lshl_b32 s72, s72, 7
    s_add_u32 s72, s72, s79
    s_add_u32 m0, s81, 0
    s_nop 0
    buffer_load_dwordx4 v112, s[8:11], s72 offen offset:0 lds
    buffer_load_dwordx4 v113, s[8:11], s72 offen offset:1024 lds
    buffer_load_dwordx4 v114, s[8:11], s72 offen offset:2048 lds
    buffer_load_dwordx4 v115, s[8:11], s72 offen offset:3072 lds
    s_add_u32 s72, s40, 1
    s_and_b32 s72, s72, 7
    s_lshl_b32 s72, s72, 7
    s_add_u32 s72, s72, s79
    s_add_u32 m0, s81, 16384
    s_nop 0
    buffer_load_dwordx4 v112, s[8:11], s72 offen offset:0 lds
    buffer_load_dwordx4 v113, s[8:11], s72 offen offset:1024 lds
    buffer_load_dwordx4 v114, s[8:11], s72 offen offset:2048 lds
    buffer_load_dwordx4 v115, s[8:11], s72 offen offset:3072 lds
    s_add_u32 s72, s40, 2
    s_and_b32 s72, s72, 7
    s_lshl_b32 s72, s72, 7
    s_add_u32 s72, s72, s79
    s_add_u32 m0, s81, 32768
    s_nop 0
    buffer_load_dwordx4 v112, s[8:11], s72 offen offset:0 lds
    buffer_load_dwordx4 v113, s[8:11], s72 offen offset:1024 lds
    buffer_load_dwordx4 v114, s[8:11], s72 offen offset:2048 lds
    buffer_load_dwordx4 v115, s[8:11], s72 offen offset:3072 lds
    s_lshr_b32 s76, s68, 1
    s_cmp_eq_u32 s76, 0
    s_cselect_b32 s36, s4, s6
    s_cselect_b32 s37, s5, s7
    s_load_dword s71, s[32:33], 0
    v_mov_b32 v18, 0xbb00bb00
    v_accvgpr_write_b32 a72, v18
    v_accvgpr_write_b32 a73, v18
    v_accvgpr_write_b32 a74, v18
    v_accvgpr_write_b32 a75, v18
    v_mov_b32 v22, 0
    v_mov_b32 v23, 0
    v_mov_b32 v24, 0
    v_mov_b32 v25, 0
    v_and_b32 v96, 31, v1
    v_bfe_u32 v97, v1, 1, 3
    v_lshrrev_b32 v98, 5, v1
    v_xor_b32 v97, v97, v98
    v_lshlrev_b32 v96, 7, v96
    v_lshl_add_u32 v96, v97, 4, v96
    v_add_u32 v120, s81, v96
    v_xor_b32 v121, 32, v120
    v_xor_b32 v122, 64, v120
    v_xor_b32 v123, 96, v120
    v_lshrrev_b32 v96, 2, v1
    v_mul_u32_u24 v96, 3072, v96
    v_and_b32 v97, 3, v1
    v_lshl_add_u32 v11, v97, 4, v96
    s_mul_i32 s78, s68, 49152
    s_lshl_b32 s76, s70, 6
    s_add_u32 s78, s78, s76
    s_lshl_b32 s80, s68, 10
    s_mul_i32 s76, s70, 43
    s_lshr_b32 s76, s76, 4
    s_add_u32 s77, s70, 1
    s_mul_i32 s77, s77, 43
    s_lshr_b32 s77, s77, 4
    s_sub_u32 s84, s77, s76
    s_lshl_b32 s85, s69, 2
    s_add_u32 s85, s85, s68
    s_mul_i32 s85, s85, 118
    s_lshl_b32 s77, s76, 1
    s_add_u32 s86, s85, s77
    s_lshl_b32 s86, s86, 10
    s_add_u32 s86, s86, 2097152
    s_lshl_b32 s75, s76, 6
    s_and_b32 s77, s68, 1
    s_mul_i32 s76, s77, 22016
    s_add_u32 s75, s75, s76
    s_lshl_b32 s82, s77, 11
    s_lshr_b32 s77, s68, 1
    s_lshl_b32 s76, s77, 12
    s_add_u32 s82, s82, s76
    s_add_u32 s82, s82, 98304
    s_lshl_b32 s94, s77, 1
    s_add_u32 s76, s40, 0
    s_and_b32 s76, s76, 7
    s_mul_i32 s77, s76, 196608
    s_add_u32 s48, s77, s78
    s_mul_i32 s77, s76, 176128
    s_add_u32 s56, s77, s75
    s_add_u32 s76, s40, 1
    s_and_b32 s76, s76, 7
    s_mul_i32 s77, s76, 196608
    s_add_u32 s49, s77, s78
    s_mul_i32 s77, s76, 176128
    s_add_u32 s57, s77, s75
    s_add_u32 s76, s40, 2
    s_and_b32 s76, s76, 7
    s_mul_i32 s77, s76, 196608
    s_add_u32 s50, s77, s78
    s_mul_i32 s77, s76, 176128
    s_add_u32 s58, s77, s75
    s_add_u32 s76, s40, 3
    s_and_b32 s76, s76, 7
    s_mul_i32 s77, s76, 196608
    s_add_u32 s51, s77, s78
    s_mul_i32 s77, s76, 176128
    s_add_u32 s59, s77, s75
    s_add_u32 s76, s40, 4
    s_and_b32 s76, s76, 7
    s_mul_i32 s77, s76, 196608
    s_add_u32 s52, s77, s78
    s_mul_i32 s77, s76, 176128
    s_add_u32 s60, s77, s75
    s_add_u32 s76, s40, 5
    s_and_b32 s76, s76, 7
    s_mul_i32 s77, s76, 196608
    s_add_u32 s53, s77, s78
    s_mul_i32 s77, s76, 176128
    s_add_u32 s61, s77, s75
    s_add_u32 s76, s40, 6
    s_and_b32 s76, s76, 7
    s_mul_i32 s77, s76, 196608
    s_add_u32 s54, s77, s78
    s_mul_i32 s77, s76, 176128
    s_add_u32 s62, s77, s75
    s_add_u32 s76, s40, 7
    s_and_b32 s76, s76, 7
    s_mul_i32 s77, s76, 196608
    s_add_u32 s55, s77, s78
    s_mul_i32 s77, s76, 176128
    s_add_u32 s63, s77, s75
    v_and_b32 v96, 31, v1
    v_bfe_u32 v97, v1, 2, 1
    v_lshrrev_b32 v98, 5, v1
    v_cmp_eq_u32 s[96:97], v97, v98
    v_and_b32 v97, 3, v96
    v_bfe_u32 v98, v96, 3, 1
    v_lshl_add_u32 v97, v98, 2, v97
    v_and_b32 v98, 1, v97
    v_lshlrev_b32 v98, 4, v98
    v_mov_b32 v99, 0x3f80
    v_lshlrev_b32 v99, v98, v99
    v_cndmask_b32 v99, 0, v99, s[96:97]
    v_lshrrev_b32 v97, 1, v97
    v_cmp_gt_u32 s[96:97], 16, v96
    s_nop 1
    v_cndmask_b32 v100, 0, v99, s[96:97]
    v_cndmask_b32 v101, v99, 0, s[96:97]
    v_cmp_eq_u32 s[96:97], 0, v97
    s_nop 1
    v_cndmask_b32 v102, 0, v100, s[96:97]
    v_cndmask_b32 v103, 0, v101, s[96:97]
    v_accvgpr_write_b32 a56, v102
    v_accvgpr_write_b32 a60, v103
    v_cmp_eq_u32 s[96:97], 1, v97
    s_nop 1
    v_cndmask_b32 v102, 0, v100, s[96:97]
    v_cndmask_b32 v103, 0, v101, s[96:97]
    v_accvgpr_write_b32 a57, v102
    v_accvgpr_write_b32 a61, v103
    v_cmp_eq_u32 s[96:97], 2, v97
    s_nop 1
    v_cndmask_b32 v102, 0, v100, s[96:97]
    v_cndmask_b32 v103, 0, v101, s[96:97]
    v_accvgpr_write_b32 a58, v102
    v_accvgpr_write_b32 a62, v103
    v_add_u32 v124, 65536, v120
    v_add_u32 v125, 65536, v121
    v_add_u32 v126, 65536, v122
    v_add_u32 v127, 65536, v123
    s_add_u32 s72, s40, 3
    s_and_b32 s72, s72, 7
    s_lshl_b32 s72, s72, 7
    s_add_u32 s72, s72, s79
    s_add_u32 m0, s81, 49152
    s_nop 0
    buffer_load_dwordx4 v112, s[8:11], s72 offen offset:0 lds
    v_cmp_eq_u32 s[96:97], 3, v97
    s_nop 1
    v_cndmask_b32 v102, 0, v100, s[96:97]
    v_cndmask_b32 v103, 0, v101, s[96:97]
    v_accvgpr_write_b32 a59, v102
    v_accvgpr_write_b32 a63, v103
    v_lshrrev_b32 v96, 4, v1
    v_and_b32 v97, 15, v1
    v_lshlrev_b32 v98, 2, v96
    v_xor_b32 v97, v97, v98
    v_xor_b32 v97, s94, v97
    buffer_load_dwordx4 v113, s[8:11], s72 offen offset:1024 lds
    v_subrev_u32 v98, 4, v97
    v_cmp_lt_u32 s[96:97], 11, v97
    s_nop 1
    v_cndmask_b32 v97, v97, v98, s[96:97]
    v_mul_u32_u24 v96, 2752, v96
    v_lshl_add_u32 v12, v97, 4, v96
    v_add_u32 v0, 9984, v12
    v_bfe_u32 v96, v1, 2, 2
    v_bfe_u32 v97, v1, 4, 1
    v_and_b32 v98, 3, v1
    v_lshrrev_b32 v99, 5, v1
    buffer_load_dwordx4 v114, s[8:11], s72 offen offset:2048 lds
    v_lshlrev_b32 v100, 6, v96
    v_lshl_add_u32 v100, v97, 5, v100
    v_lshl_add_u32 v100, v98, 3, v100
    v_lshl_add_u32 v3, v99, 9, v100
    v_add_u32 v4, 65536, v3
    v_lshl_add_u32 v100, v99, 3, v96
    v_lshlrev_b32 v100, 8, v100
    v_lshl_add_u32 v100, v97, 12, v100
    v_and_b32 v101, 1, v98
    v_lshl_add_u32 v101, v97, 1, v101
    buffer_load_dwordx4 v115, s[8:11], s72 offen offset:3072 lds
    v_lshl_add_u32 v101, v96, 2, v101
    v_lshl_add_u32 v100, v101, 4, v100
    v_lshrrev_b32 v101, 1, v98
    v_lshl_add_u32 v100, v101, 3, v100
    v_add_u32 v5, 98304, v100
    v_xor_b32 v6, 32, v5
    v_xor_b32 v7, 64, v5
    v_xor_b32 v8, 96, v5
    v_xor_b32 v9, 128, v5
    v_xor_b32 v10, 160, v5
    s_add_u32 s72, s40, 4
    s_and_b32 s72, s72, 7
    s_lshl_b32 s72, s72, 7
    s_add_u32 s72, s72, s79
    s_add_u32 m0, s81, 65536
    s_nop 0
    buffer_load_dwordx4 v112, s[8:11], s72 offen offset:0 lds
    v_lshrrev_b32 v96, 3, v1
    v_lshlrev_b32 v96, 10, v96
    v_and_b32 v97, 7, v1
    v_bfe_u32 v98, v1, 4, 1
    v_lshlrev_b32 v98, 2, v98
    v_xor_b32 v97, v97, v98
    v_lshl_add_u32 v13, v97, 4, v96
    s_lshl_b32 s89, s68, 14
    s_lshl_b32 s76, s88, 7
    s_add_u32 s89, s89, s76
    buffer_load_dwordx4 v113, s[8:11], s72 offen offset:1024 lds
    s_mul_i32 s90, s68, 22528
    s_lshl_b32 s91, s68, 11
    s_and_b32 s77, s87, 3
    s_lshl_b32 s77, s77, 1
    s_add_u32 s76, s77, s88
    s_mul_i32 s76, s76, 3
    s_sub_u32 s75, s76, 22
    s_cmp_ge_u32 s76, 22
    s_cselect_b32 s76, s75, s76
    s_add_u32 s77, s77, s88
    buffer_load_dwordx4 v114, s[8:11], s72 offen offset:2048 lds
    s_and_b32 s77, s77, 7
    s_lshl_b32 s42, s76, 16
    s_add_u32 s42, s42, s89
    s_add_u32 s44, s89, 1441792
    s_lshl_b32 s45, s77, 16
    s_add_u32 s45, s45, s89
    s_and_b32 s76, s68, 1
    s_lshl_b32 s77, s70, 1
    s_add_u32 s76, s76, s77
    s_lshl_b32 s76, s76, 15
    buffer_load_dwordx4 v115, s[8:11], s72 offen offset:3072 lds
    s_lshr_b32 s77, s68, 1
    s_lshl_b32 s77, s77, 14
    s_add_u32 s76, s76, s77
    s_add_u32 s95, s76, 65536
    v_bfe_u32 v97, v1, 2, 2
    v_bfe_u32 v98, v1, 4, 1
    v_and_b32 v99, 3, v1
    v_lshrrev_b32 v100, 5, v1
    v_lshl_add_u32 v101, v100, 2, v97
    v_lshlrev_b32 v101, 5, v101
    s_add_u32 s72, s40, 5
    s_and_b32 s72, s72, 7
    s_lshl_b32 s72, s72, 7
    s_add_u32 s72, s72, s79
    s_add_u32 m0, s81, 81920
    s_nop 0
    buffer_load_dwordx4 v112, s[8:11], s72 offen offset:0 lds
    v_and_b32 v102, 1, v99
    v_lshl_add_u32 v101, v102, 9, v101
    v_lshrrev_b32 v102, 1, v99
    v_lshl_add_u32 v102, v98, 1, v102
    v_lshl_add_u32 v101, v102, 3, v101
    v_add_u32 v101, 0, v101
    s_waitcnt vmcnt(21)
    ds_read_b64_tr_b16 v[104:105], v101
    ds_read_b64_tr_b16 v[106:107], v101 offset:256
    v_bfe_u32 v97, v1, 2, 1
    buffer_load_dwordx4 v113, s[8:11], s72 offen offset:1024 lds
    v_cmp_eq_u32 s[96:97], 0, v97
    s_waitcnt lgkmcnt(0)
    s_nop 0
    v_cndmask_b32 v98, 0, v104, s[96:97]
    v_cndmask_b32 v99, v104, 0, s[96:97]
    v_accvgpr_write_b32 a48, v98
    v_accvgpr_write_b32 a52, v99
    v_cndmask_b32 v98, 0, v105, s[96:97]
    v_cndmask_b32 v99, v105, 0, s[96:97]
    v_accvgpr_write_b32 a49, v98
    v_accvgpr_write_b32 a53, v99
    buffer_load_dwordx4 v114, s[8:11], s72 offen offset:2048 lds
    v_cndmask_b32 v98, 0, v106, s[96:97]
    v_cndmask_b32 v99, v106, 0, s[96:97]
    v_accvgpr_write_b32 a50, v98
    v_accvgpr_write_b32 a54, v99
    v_cndmask_b32 v98, 0, v107, s[96:97]
    v_cndmask_b32 v99, v107, 0, s[96:97]
    v_accvgpr_write_b32 a51, v98
    v_accvgpr_write_b32 a55, v99
    s_waitcnt vmcnt(19)
    ds_read_b128 v[128:131], v120 offset:0
    ds_read_b128 v[132:135], v121 offset:0
    ds_read_b128 v[136:139], v122 offset:0
    ds_read_b128 v[140:143], v123 offset:0
    buffer_load_dwordx4 v115, s[8:11], s72 offen offset:3072 lds
    s_waitcnt vmcnt(16)
    ds_read_b128 v[144:147], v120 offset:16384
    ds_read_b128 v[148:151], v121 offset:16384
    ds_read_b128 v[152:155], v122 offset:16384
    ds_read_b128 v[156:159], v123 offset:16384
    s_waitcnt lgkmcnt(4)
    v_dot2_f32_bf16 v22, v128, v128, v22
    v_dot2_f32_bf16 v23, v129, v129, v23
    v_dot2_f32_bf16 v24, v130, v130, v24
    v_dot2_f32_bf16 v25, v131, v131, v25
    s_add_u32 s72, s40, 6
    s_and_b32 s72, s72, 7
    s_lshl_b32 s72, s72, 7
    s_add_u32 s72, s72, s79
    s_add_u32 m0, s81, 98304
    s_nop 0
    buffer_load_dwordx4 v112, s[8:11], s72 offen offset:0 lds
    v_dot2_f32_bf16 v22, v132, v132, v22
    v_dot2_f32_bf16 v23, v133, v133, v23
    v_dot2_f32_bf16 v24, v134, v134, v24
    v_dot2_f32_bf16 v25, v135, v135, v25
    v_dot2_f32_bf16 v22, v136, v136, v22
    v_dot2_f32_bf16 v23, v137, v137, v23
    v_dot2_f32_bf16 v24, v138, v138, v24
    v_dot2_f32_bf16 v25, v139, v139, v25
    v_dot2_f32_bf16 v22, v140, v140, v22
    v_dot2_f32_bf16 v23, v141, v141, v23
    buffer_load_dwordx4 v113, s[8:11], s72 offen offset:1024 lds
    v_dot2_f32_bf16 v24, v142, v142, v24
    v_dot2_f32_bf16 v25, v143, v143, v25
    v_mfma_f32_32x32x16_bf16 v[64:79], a[72:75], v[128:131], 0
    v_mfma_f32_32x32x16_bf16 v[64:79], a[72:75], v[132:135], v[64:79]
    v_mfma_f32_32x32x16_bf16 v[64:79], a[72:75], v[136:139], v[64:79]
    v_mfma_f32_32x32x16_bf16 v[64:79], a[72:75], v[140:143], v[64:79]
    buffer_load_dwordx4 v114, s[8:11], s72 offen offset:2048 lds
    s_waitcnt vmcnt(15)
    ds_read_b128 v[160:163], v120 offset:32768
    ds_read_b128 v[164:167], v121 offset:32768
    ds_read_b128 v[168:171], v122 offset:32768
    ds_read_b128 v[172:175], v123 offset:32768
    s_waitcnt lgkmcnt(4)
    v_dot2_f32_bf16 v22, v144, v144, v22
    v_dot2_f32_bf16 v23, v145, v145, v23
    v_dot2_f32_bf16 v24, v146, v146, v24
    v_dot2_f32_bf16 v25, v147, v147, v25
    buffer_load_dwordx4 v115, s[8:11], s72 offen offset:3072 lds
    v_dot2_f32_bf16 v22, v148, v148, v22
    v_dot2_f32_bf16 v23, v149, v149, v23
    v_dot2_f32_bf16 v24, v150, v150, v24
    v_dot2_f32_bf16 v25, v151, v151, v25
    v_dot2_f32_bf16 v22, v152, v152, v22
    v_dot2_f32_bf16 v23, v153, v153, v23
    v_dot2_f32_bf16 v24, v154, v154, v24
    v_dot2_f32_bf16 v25, v155, v155, v25
    v_dot2_f32_bf16 v22, v156, v156, v22
    v_dot2_f32_bf16 v23, v157, v157, v23
    s_add_u32 s72, s40, 7
    s_and_b32 s72, s72, 7
    s_lshl_b32 s72, s72, 7
    s_add_u32 s72, s72, s79
    s_add_u32 m0, s81, 114688
    s_nop 0
    buffer_load_dwordx4 v112, s[8:11], s72 offen offset:0 lds
    v_dot2_f32_bf16 v24, v158, v158, v24
    v_dot2_f32_bf16 v25, v159, v159, v25
    v_mfma_f32_32x32x16_bf16 v[64:79], a[72:75], v[144:147], v[64:79]
    v_mfma_f32_32x32x16_bf16 v[64:79], a[72:75], v[148:151], v[64:79]
    v_mfma_f32_32x32x16_bf16 v[64:79], a[72:75], v[152:155], v[64:79]
    v_mfma_f32_32x32x16_bf16 v[64:79], a[72:75], v[156:159], v[64:79]
    buffer_load_dwordx4 v113, s[8:11], s72 offen offset:1024 lds
    s_waitcnt vmcnt(14)
    ds_read_b128 v[176:179], v120 offset:49152
    ds_read_b128 v[180:183], v121 offset:49152
    ds_read_b128 v[184:187], v122 offset:49152
    ds_read_b128 v[188:191], v123 offset:49152
    s_barrier
    s_waitcnt lgkmcnt(4)
    v_dot2_f32_bf16 v22, v160, v160, v22
    v_dot2_f32_bf16 v23, v161, v161, v23
    v_dot2_f32_bf16 v24, v162, v162, v24
    buffer_load_dwordx4 v114, s[8:11], s72 offen offset:2048 lds
    v_dot2_f32_bf16 v25, v163, v163, v25
    v_dot2_f32_bf16 v22, v164, v164, v22
    v_dot2_f32_bf16 v23, v165, v165, v23
    v_dot2_f32_bf16 v24, v166, v166, v24
    v_dot2_f32_bf16 v25, v167, v167, v25
    v_dot2_f32_bf16 v22, v168, v168, v22
    v_dot2_f32_bf16 v23, v169, v169, v23
    v_dot2_f32_bf16 v24, v170, v170, v24
    v_dot2_f32_bf16 v25, v171, v171, v25
    v_dot2_f32_bf16 v22, v172, v172, v22
    buffer_load_dwordx4 v115, s[8:11], s72 offen offset:3072 lds
    v_dot2_f32_bf16 v23, v173, v173, v23
    v_dot2_f32_bf16 v24, v174, v174, v24
    v_dot2_f32_bf16 v25, v175, v175, v25
    v_mfma_f32_32x32x16_bf16 v[64:79], a[72:75], v[160:163], v[64:79]
    v_mfma_f32_32x32x16_bf16 v[64:79], a[72:75], v[164:167], v[64:79]
    v_mfma_f32_32x32x16_bf16 v[64:79], a[72:75], v[168:171], v[64:79]
    v_mfma_f32_32x32x16_bf16 v[64:79], a[72:75], v[172:175], v[64:79]
    s_add_u32 s83, s48, 1024
    s_add_u32 m0, s80, 0
    s_nop 0
    buffer_load_dwordx4 v11, s[12:15], s83 offen lds
    s_waitcnt vmcnt(13)
    ds_read_b128 v[192:195], v124 offset:0
    ds_read_b128 v[196:199], v125 offset:0
    ds_read_b128 v[200:203], v126 offset:0
    ds_read_b128 v[204:207], v127 offset:0
    s_waitcnt lgkmcnt(4)
    v_dot2_f32_bf16 v22, v176, v176, v22
    v_dot2_f32_bf16 v23, v177, v177, v23
    v_dot2_f32_bf16 v24, v178, v178, v24
    v_dot2_f32_bf16 v25, v179, v179, v25
    s_add_u32 s83, s49, 1024
    s_add_u32 m0, s80, 4096
    s_nop 0
    buffer_load_dwordx4 v11, s[12:15], s83 offen lds
    v_dot2_f32_bf16 v22, v180, v180, v22
    v_dot2_f32_bf16 v23, v181, v181, v23
    v_dot2_f32_bf16 v24, v182, v182, v24
    v_dot2_f32_bf16 v25, v183, v183, v25
    v_dot2_f32_bf16 v22, v184, v184, v22
    v_dot2_f32_bf16 v23, v185, v185, v23
    v_dot2_f32_bf16 v24, v186, v186, v24
    v_dot2_f32_bf16 v25, v187, v187, v25
    v_dot2_f32_bf16 v22, v188, v188, v22
    v_dot2_f32_bf16 v23, v189, v189, v23
    s_add_u32 s83, s50, 1024
    s_add_u32 m0, s80, 8192
    s_nop 0
    buffer_load_dwordx4 v11, s[12:15], s83 offen lds
    v_dot2_f32_bf16 v24, v190, v190, v24
    v_dot2_f32_bf16 v25, v191, v191, v25
    v_mfma_f32_32x32x16_bf16 v[64:79], a[72:75], v[176:179], v[64:79]
    v_mfma_f32_32x32x16_bf16 v[64:79], a[72:75], v[180:183], v[64:79]
    v_mfma_f32_32x32x16_bf16 v[64:79], a[72:75], v[184:187], v[64:79]
    v_mfma_f32_32x32x16_bf16 v[64:79], a[72:75], v[188:191], v[64:79]
    s_add_u32 s83, s51, 1024
    s_add_u32 m0, s80, 12288
    s_nop 0
    buffer_load_dwordx4 v11, s[12:15], s83 offen lds
    s_waitcnt vmcnt(12)
    ds_read_b128 v[208:211], v124 offset:16384
    ds_read_b128 v[212:215], v125 offset:16384
    ds_read_b128 v[216:219], v126 offset:16384
    ds_read_b128 v[220:223], v127 offset:16384
    s_barrier
    s_waitcnt lgkmcnt(4)
    v_dot2_f32_bf16 v22, v192, v192, v22
    v_dot2_f32_bf16 v23, v193, v193, v23
    v_dot2_f32_bf16 v24, v194, v194, v24
    s_add_u32 s83, s52, 1024
    s_add_u32 m0, s80, 16384
    s_nop 0
    buffer_load_dwordx4 v11, s[12:15], s83 offen lds
    v_dot2_f32_bf16 v25, v195, v195, v25
    v_dot2_f32_bf16 v22, v196, v196, v22
    v_dot2_f32_bf16 v23, v197, v197, v23
    v_dot2_f32_bf16 v24, v198, v198, v24
    v_dot2_f32_bf16 v25, v199, v199, v25
    v_dot2_f32_bf16 v22, v200, v200, v22
    v_dot2_f32_bf16 v23, v201, v201, v23
    v_dot2_f32_bf16 v24, v202, v202, v24
    v_dot2_f32_bf16 v25, v203, v203, v25
    v_dot2_f32_bf16 v22, v204, v204, v22
    s_add_u32 s83, s53, 1024
    s_add_u32 m0, s80, 20480
    s_nop 0
    buffer_load_dwordx4 v11, s[12:15], s83 offen lds
    v_dot2_f32_bf16 v23, v205, v205, v23
    v_dot2_f32_bf16 v24, v206, v206, v24
    v_dot2_f32_bf16 v25, v207, v207, v25
    v_mfma_f32_32x32x16_bf16 v[64:79], a[72:75], v[192:195], v[64:79]
    v_mfma_f32_32x32x16_bf16 v[64:79], a[72:75], v[196:199], v[64:79]
    v_mfma_f32_32x32x16_bf16 v[64:79], a[72:75], v[200:203], v[64:79]
    v_mfma_f32_32x32x16_bf16 v[64:79], a[72:75], v[204:207], v[64:79]
    s_add_u32 s83, s54, 1024
    s_add_u32 m0, s80, 24576
    s_nop 0
    buffer_load_dwordx4 v11, s[12:15], s83 offen lds
    s_waitcnt vmcnt(11)
    ds_read_b128 v[224:227], v124 offset:32768
    ds_read_b128 v[228:231], v125 offset:32768
    ds_read_b128 v[232:235], v126 offset:32768
    ds_read_b128 v[236:239], v127 offset:32768
    s_waitcnt lgkmcnt(4)
    v_dot2_f32_bf16 v22, v208, v208, v22
    v_dot2_f32_bf16 v23, v209, v209, v23
    v_dot2_f32_bf16 v24, v210, v210, v24
    v_dot2_f32_bf16 v25, v211, v211, v25
    s_add_u32 s83, s55, 1024
    s_add_u32 m0, s80, 28672
    s_nop 0
    buffer_load_dwordx4 v11, s[12:15], s83 offen lds
    v_dot2_f32_bf16 v22, v212, v212, v22
    v_dot2_f32_bf16 v23, v213, v213, v23
    v_dot2_f32_bf16 v24, v214, v214, v24
    v_dot2_f32_bf16 v25, v215, v215, v25
    v_dot2_f32_bf16 v22, v216, v216, v22
    v_dot2_f32_bf16 v23, v217, v217, v23
    v_dot2_f32_bf16 v24, v218, v218, v24
    v_dot2_f32_bf16 v25, v219, v219, v25
    v_dot2_f32_bf16 v22, v220, v220, v22
    v_dot2_f32_bf16 v23, v221, v221, v23
    s_add_u32 s83, s48, 2048
    s_add_u32 m0, s80, 32768
    s_nop 0
    buffer_load_dwordx4 v11, s[12:15], s83 offen lds
    v_dot2_f32_bf16 v24, v222, v222, v24
    v_dot2_f32_bf16 v25, v223, v223, v25
    v_mfma_f32_32x32x16_bf16 v[64:79], a[72:75], v[208:211], v[64:79]
    v_mfma_f32_32x32x16_bf16 v[64:79], a[72:75], v[212:215], v[64:79]
    v_mfma_f32_32x32x16_bf16 v[64:79], a[72:75], v[216:219], v[64:79]
    v_mfma_f32_32x32x16_bf16 v[64:79], a[72:75], v[220:223], v[64:79]
    s_add_u32 s83, s49, 2048
    s_add_u32 m0, s80, 36864
    s_nop 0
    buffer_load_dwordx4 v11, s[12:15], s83 offen lds
    s_waitcnt vmcnt(10)
    ds_read_b128 v[240:243], v124 offset:49152
    ds_read_b128 v[244:247], v125 offset:49152
    ds_read_b128 v[248:251], v126 offset:49152
    ds_read_b128 v[252:255], v127 offset:49152
    s_waitcnt lgkmcnt(4)
    v_dot2_f32_bf16 v22, v224, v224, v22
    v_dot2_f32_bf16 v23, v225, v225, v23
    v_dot2_f32_bf16 v24, v226, v226, v24
    v_dot2_f32_bf16 v25, v227, v227, v25
    s_add_u32 s83, s50, 2048
    s_add_u32 m0, s80, 40960
    s_nop 0
    buffer_load_dwordx4 v11, s[12:15], s83 offen lds
    v_dot2_f32_bf16 v22, v228, v228, v22
    v_dot2_f32_bf16 v23, v229, v229, v23
    v_dot2_f32_bf16 v24, v230, v230, v24
    v_dot2_f32_bf16 v25, v231, v231, v25
    v_dot2_f32_bf16 v22, v232, v232, v22
    v_dot2_f32_bf16 v23, v233, v233, v23
    v_dot2_f32_bf16 v24, v234, v234, v24
    v_dot2_f32_bf16 v25, v235, v235, v25
    v_dot2_f32_bf16 v22, v236, v236, v22
    v_dot2_f32_bf16 v23, v237, v237, v23
    s_add_u32 s83, s51, 2048
    s_add_u32 m0, s80, 45056
    s_nop 0
    buffer_load_dwordx4 v11, s[12:15], s83 offen lds
    v_dot2_f32_bf16 v24, v238, v238, v24
    v_dot2_f32_bf16 v25, v239, v239, v25
    v_mfma_f32_32x32x16_bf16 v[64:79], a[72:75], v[224:227], v[64:79]
    v_mfma_f32_32x32x16_bf16 v[64:79], a[72:75], v[228:231], v[64:79]
    v_mfma_f32_32x32x16_bf16 v[64:79], a[72:75], v[232:235], v[64:79]
    v_mfma_f32_32x32x16_bf16 v[64:79], a[72:75], v[236:239], v[64:79]
    s_add_u32 s83, s52, 2048
    s_add_u32 m0, s80, 49152
    s_nop 0
    buffer_load_dwordx4 v11, s[12:15], s83 offen lds
    s_waitcnt lgkmcnt(0)
    v_dot2_f32_bf16 v22, v240, v240, v22
    v_dot2_f32_bf16 v23, v241, v241, v23
    v_dot2_f32_bf16 v24, v242, v242, v24
    v_dot2_f32_bf16 v25, v243, v243, v25
    v_dot2_f32_bf16 v22, v244, v244, v22
    v_dot2_f32_bf16 v23, v245, v245, v23
    v_dot2_f32_bf16 v24, v246, v246, v24
    v_dot2_f32_bf16 v25, v247, v247, v25
    v_dot2_f32_bf16 v22, v248, v248, v22
    s_add_u32 s83, s53, 2048
    s_add_u32 m0, s80, 53248
    s_nop 0
    buffer_load_dwordx4 v11, s[12:15], s83 offen lds
    v_dot2_f32_bf16 v23, v249, v249, v23
    v_dot2_f32_bf16 v24, v250, v250, v24
    v_dot2_f32_bf16 v25, v251, v251, v25
    v_dot2_f32_bf16 v22, v252, v252, v22
    v_dot2_f32_bf16 v23, v253, v253, v23
    v_dot2_f32_bf16 v24, v254, v254, v24
    v_dot2_f32_bf16 v25, v255, v255, v25
    v_mfma_f32_32x32x16_bf16 v[64:79], a[72:75], v[240:243], v[64:79]
    v_mfma_f32_32x32x16_bf16 v[64:79], a[72:75], v[244:247], v[64:79]
    s_add_u32 s83, s54, 2048
    s_add_u32 m0, s80, 57344
    s_nop 0
    buffer_load_dwordx4 v11, s[12:15], s83 offen lds
    v_mfma_f32_32x32x16_bf16 v[64:79], a[72:75], v[248:251], v[64:79]
    v_mfma_f32_32x32x16_bf16 v[64:79], a[72:75], v[252:255], v[64:79]
    v_add_f32 v22, v22, v23
    v_add_f32 v24, v24, v25
    v_add_f32 v22, v22, v24
    v_mov_b32 v23, v22
    s_nop 1
    v_permlane32_swap_b32 v22, v23
    s_nop 0
    v_add_f32 v22, v22, v23
    v_mul_f32 v22, 0x3b000000, v22
    s_nop 1
    v_fma_f32 v22, -v64, v64, v22
    v_max_f32 v22, 0, v22
    v_add_f32 v22, 0x3727c5ac, v22
    v_rsq_f32 v17, v22
    v_add_u32 v14, 7168, v13
    v_mul_f32 v15, 0x3fb8aa3b, v17
    v_mul_f32 v16, v17, v17
    s_waitcnt lgkmcnt(0)
    s_add_u32 s71, s71, 1
    s_barrier
    v_mfma_f32_32x32x16_bf16 v[80:95], a[56:59], v[128:131], v[64:79]
    v_mfma_f32_32x32x16_bf16 v[80:95], a[60:63], v[132:135], v[80:95]
    v_mfma_f32_32x32x16_bf16 v[96:111], a[56:59], v[136:139], v[64:79]
    v_mfma_f32_32x32x16_bf16 v[96:111], a[60:63], v[140:143], v[96:111]
    v_mfma_f32_32x32x16_bf16 v[112:127], a[56:59], v[144:147], v[64:79]
    v_mfma_f32_32x32x16_bf16 v[112:127], a[60:63], v[148:151], v[112:127]
    s_waitcnt vmcnt(13)
    s_barrier
    ds_read_b64_tr_b16 a[0:1], v3 offset:0
    ds_read_b64_tr_b16 a[2:3], v3 offset:256
    ds_read_b64_tr_b16 a[4:5], v3 offset:1024
    ds_read_b64_tr_b16 a[6:7], v3 offset:1280
    ds_read_b64_tr_b16 a[8:9], v3 offset:2048
    ds_read_b64_tr_b16 a[10:11], v3 offset:2304
    ds_read_b64_tr_b16 a[12:13], v3 offset:3072
    ds_read_b64_tr_b16 a[14:15], v3 offset:3328
    v_cvt_pk_bf16_f32 v128, v80, v81
    v_cvt_pk_bf16_f32 v129, v82, v83
    v_cvt_pk_bf16_f32 v130, v84, v85
    v_cvt_pk_bf16_f32 v131, v86, v87
    v_cvt_pk_bf16_f32 v132, v88, v89
    v_cvt_pk_bf16_f32 v133, v90, v91
    v_cvt_pk_bf16_f32 v134, v92, v93
    v_cvt_pk_bf16_f32 v135, v94, v95
    s_waitcnt lgkmcnt(4)
    v_mfma_f32_32x32x16_bf16 v[32:47], a[0:3], v[128:131], 0
    v_cvt_pk_bf16_f32 v136, v96, v97
    v_cvt_pk_bf16_f32 v137, v98, v99
    v_cvt_pk_bf16_f32 v138, v100, v101
    v_cvt_pk_bf16_f32 v139, v102, v103
    v_mfma_f32_32x32x16_bf16 v[80:95], a[56:59], v[152:155], v[64:79]
    ds_read_b64_tr_b16 a[16:17], v3 offset:4096
    ds_read_b64_tr_b16 a[18:19], v3 offset:4352
    s_add_u32 s83, s55, 2048
    s_add_u32 m0, s80, 61440
    v_mfma_f32_32x32x16_bf16 v[32:47], a[4:7], v[132:135], v[32:47]
    v_cvt_pk_bf16_f32 v140, v104, v105
    v_cvt_pk_bf16_f32 v141, v106, v107
    v_cvt_pk_bf16_f32 v142, v108, v109
    v_cvt_pk_bf16_f32 v143, v110, v111
    v_mfma_f32_32x32x16_bf16 v[80:95], a[60:63], v[156:159], v[80:95]
    ds_read_b64_tr_b16 a[20:21], v3 offset:5120
    ds_read_b64_tr_b16 a[22:23], v3 offset:5376
    buffer_load_dwordx4 v11, s[12:15], s83 offen lds
    s_waitcnt lgkmcnt(4)
    v_mfma_f32_32x32x16_bf16 v[32:47], a[8:11], v[136:139], v[32:47]
    v_cvt_pk_bf16_f32 v144, v112, v113
    v_cvt_pk_bf16_f32 v145, v114, v115
    v_cvt_pk_bf16_f32 v146, v116, v117
    v_cvt_pk_bf16_f32 v147, v118, v119
    v_mfma_f32_32x32x16_bf16 v[96:111], a[56:59], v[160:163], v[64:79]
    ds_read_b64_tr_b16 a[24:25], v3 offset:6144
    ds_read_b64_tr_b16 a[26:27], v3 offset:6400
    s_add_u32 s83, s48, 0
    s_add_u32 m0, s80, 65536
    v_mfma_f32_32x32x16_bf16 v[32:47], a[12:15], v[140:143], v[32:47]
    v_cvt_pk_bf16_f32 v148, v120, v121
    v_cvt_pk_bf16_f32 v149, v122, v123
    v_cvt_pk_bf16_f32 v150, v124, v125
    v_cvt_pk_bf16_f32 v151, v126, v127
    v_mfma_f32_32x32x16_bf16 v[96:111], a[60:63], v[164:167], v[96:111]
    ds_read_b64_tr_b16 a[28:29], v3 offset:7168
    ds_read_b64_tr_b16 a[30:31], v3 offset:7424
    buffer_load_dwordx4 v11, s[12:15], s83 offen lds
    s_waitcnt vmcnt(13)
    s_barrier
    s_waitcnt lgkmcnt(4)
    v_mfma_f32_32x32x16_bf16 v[32:47], a[16:19], v[144:147], v[32:47]
    v_cvt_pk_bf16_f32 v152, v80, v81
    v_cvt_pk_bf16_f32 v153, v82, v83
    v_cvt_pk_bf16_f32 v154, v84, v85
    v_cvt_pk_bf16_f32 v155, v86, v87
    v_mfma_f32_32x32x16_bf16 v[112:127], a[56:59], v[168:171], v[64:79]
    ds_read_b64_tr_b16 a[0:1], v3 offset:8192
    ds_read_b64_tr_b16 a[2:3], v3 offset:8448
    s_add_u32 s83, s49, 0
    s_add_u32 m0, s80, 69632
    v_mfma_f32_32x32x16_bf16 v[32:47], a[20:23], v[148:151], v[32:47]
    v_cvt_pk_bf16_f32 v156, v88, v89
    v_cvt_pk_bf16_f32 v157, v90, v91
    v_cvt_pk_bf16_f32 v158, v92, v93
    v_cvt_pk_bf16_f32 v159, v94, v95
    v_mfma_f32_32x32x16_bf16 v[112:127], a[60:63], v[172:175], v[112:127]
    ds_read_b64_tr_b16 a[4:5], v3 offset:9216
    ds_read_b64_tr_b16 a[6:7], v3 offset:9472
    buffer_load_dwordx4 v11, s[12:15], s83 offen lds
    s_waitcnt lgkmcnt(4)
    v_mfma_f32_32x32x16_bf16 v[32:47], a[24:27], v[152:155], v[32:47]
    v_cvt_pk_bf16_f32 v160, v96, v97
    v_cvt_pk_bf16_f32 v161, v98, v99
    v_cvt_pk_bf16_f32 v162, v100, v101
    v_cvt_pk_bf16_f32 v163, v102, v103
    v_mfma_f32_32x32x16_bf16 v[80:95], a[56:59], v[176:179], v[64:79]
    ds_read_b64_tr_b16 a[8:9], v3 offset:10240
    ds_read_b64_tr_b16 a[10:11], v3 offset:10496
    s_add_u32 s83, s50, 0
    s_add_u32 m0, s80, 73728
    v_mfma_f32_32x32x16_bf16 v[32:47], a[28:31], v[156:159], v[32:47]
    v_cvt_pk_bf16_f32 v164, v104, v105
    v_cvt_pk_bf16_f32 v165, v106, v107
    v_cvt_pk_bf16_f32 v166, v108, v109
    v_cvt_pk_bf16_f32 v167, v110, v111
    v_mfma_f32_32x32x16_bf16 v[80:95], a[60:63], v[180:183], v[80:95]
    ds_read_b64_tr_b16 a[12:13], v3 offset:11264
    ds_read_b64_tr_b16 a[14:15], v3 offset:11520
    buffer_load_dwordx4 v11, s[12:15], s83 offen lds
    s_waitcnt lgkmcnt(4)
    v_mfma_f32_32x32x16_bf16 v[32:47], a[0:3], v[160:163], v[32:47]
    v_cvt_pk_bf16_f32 v168, v112, v113
    v_cvt_pk_bf16_f32 v169, v114, v115
    v_cvt_pk_bf16_f32 v170, v116, v117
    v_cvt_pk_bf16_f32 v171, v118, v119
    v_mfma_f32_32x32x16_bf16 v[96:111], a[56:59], v[184:187], v[64:79]
    ds_read_b64_tr_b16 a[16:17], v3 offset:12288
    ds_read_b64_tr_b16 a[18:19], v3 offset:12544
    s_add_u32 s83, s51, 0
    s_add_u32 m0, s80, 77824
    v_mfma_f32_32x32x16_bf16 v[32:47], a[4:7], v[164:167], v[32:47]
    v_cvt_pk_bf16_f32 v172, v120, v121
    v_cvt_pk_bf16_f32 v173, v122, v123
    v_cvt_pk_bf16_f32 v174, v124, v125
    v_cvt_pk_bf16_f32 v175, v126, v127
    v_mfma_f32_32x32x16_bf16 v[96:111], a[60:63], v[188:191], v[96:111]
    ds_read_b64_tr_b16 a[20:21], v3 offset:13312
    ds_read_b64_tr_b16 a[22:23], v3 offset:13568
    buffer_load_dwordx4 v11, s[12:15], s83 offen lds
    s_waitcnt lgkmcnt(4)
    v_mfma_f32_32x32x16_bf16 v[32:47], a[8:11], v[168:171], v[32:47]
    v_cvt_pk_bf16_f32 v176, v80, v81
    v_cvt_pk_bf16_f32 v177, v82, v83
    v_cvt_pk_bf16_f32 v178, v84, v85
    v_cvt_pk_bf16_f32 v179, v86, v87
    v_mfma_f32_32x32x16_bf16 v[112:127], a[56:59], v[192:195], v[64:79]
    ds_read_b64_tr_b16 a[24:25], v3 offset:14336
    ds_read_b64_tr_b16 a[26:27], v3 offset:14592
    s_add_u32 s83, s52, 0
    s_add_u32 m0, s80, 81920
    v_mfma_f32_32x32x16_bf16 v[32:47], a[12:15], v[172:175], v[32:47]
    v_cvt_pk_bf16_f32 v180, v88, v89
    v_cvt_pk_bf16_f32 v181, v90, v91
    v_cvt_pk_bf16_f32 v182, v92, v93
    v_cvt_pk_bf16_f32 v183, v94, v95
    v_mfma_f32_32x32x16_bf16 v[112:127], a[60:63], v[196:199], v[112:127]
    ds_read_b64_tr_b16 a[28:29], v3 offset:15360
    ds_read_b64_tr_b16 a[30:31], v3 offset:15616
    buffer_load_dwordx4 v11, s[12:15], s83 offen lds
    s_waitcnt vmcnt(15)
    s_barrier
    s_waitcnt lgkmcnt(4)
    v_mfma_f32_32x32x16_bf16 v[32:47], a[16:19], v[176:179], v[32:47]
    v_cvt_pk_bf16_f32 v184, v96, v97
    v_cvt_pk_bf16_f32 v185, v98, v99
    v_cvt_pk_bf16_f32 v186, v100, v101
    v_cvt_pk_bf16_f32 v187, v102, v103
    v_mfma_f32_32x32x16_bf16 v[80:95], a[56:59], v[200:203], v[64:79]
    ds_read_b64_tr_b16 a[0:1], v3 offset:16384
    ds_read_b64_tr_b16 a[2:3], v3 offset:16640
    s_add_u32 s83, s53, 0
    s_add_u32 m0, s80, 86016
    v_mfma_f32_32x32x16_bf16 v[32:47], a[20:23], v[180:183], v[32:47]
    v_cvt_pk_bf16_f32 v188, v104, v105
    v_cvt_pk_bf16_f32 v189, v106, v107
    v_cvt_pk_bf16_f32 v190, v108, v109
    v_cvt_pk_bf16_f32 v191, v110, v111
    v_mfma_f32_32x32x16_bf16 v[80:95], a[60:63], v[204:207], v[80:95]
    ds_read_b64_tr_b16 a[4:5], v3 offset:17408
    ds_read_b64_tr_b16 a[6:7], v3 offset:17664
    buffer_load_dwordx4 v11, s[12:15], s83 offen lds
    s_waitcnt lgkmcnt(4)
    v_mfma_f32_32x32x16_bf16 v[32:47], a[24:27], v[184:187], v[32:47]
    v_cvt_pk_bf16_f32 v192, v112, v113
    v_cvt_pk_bf16_f32 v193, v114, v115
    v_cvt_pk_bf16_f32 v194, v116, v117
    v_cvt_pk_bf16_f32 v195, v118, v119
    v_mfma_f32_32x32x16_bf16 v[96:111], a[56:59], v[208:211], v[64:79]
    ds_read_b64_tr_b16 a[8:9], v3 offset:18432
    ds_read_b64_tr_b16 a[10:11], v3 offset:18688
    s_add_u32 s83, s54, 0
    s_add_u32 m0, s80, 90112
    v_mfma_f32_32x32x16_bf16 v[32:47], a[28:31], v[188:191], v[32:47]
    v_cvt_pk_bf16_f32 v196, v120, v121
    v_cvt_pk_bf16_f32 v197, v122, v123
    v_cvt_pk_bf16_f32 v198, v124, v125
    v_cvt_pk_bf16_f32 v199, v126, v127
    v_mfma_f32_32x32x16_bf16 v[96:111], a[60:63], v[212:215], v[96:111]
    ds_read_b64_tr_b16 a[12:13], v3 offset:19456
    ds_read_b64_tr_b16 a[14:15], v3 offset:19712
    buffer_load_dwordx4 v11, s[12:15], s83 offen lds
    s_waitcnt lgkmcnt(4)
    v_mfma_f32_32x32x16_bf16 v[32:47], a[0:3], v[192:195], v[32:47]
    v_cvt_pk_bf16_f32 v200, v80, v81
    v_cvt_pk_bf16_f32 v201, v82, v83
    v_cvt_pk_bf16_f32 v202, v84, v85
    v_cvt_pk_bf16_f32 v203, v86, v87
    v_mfma_f32_32x32x16_bf16 v[112:127], a[56:59], v[216:219], v[64:79]
    ds_read_b64_tr_b16 a[16:17], v3 offset:20480
    ds_read_b64_tr_b16 a[18:19], v3 offset:20736
    s_add_u32 s83, s55, 0
    s_add_u32 m0, s80, 94208
    v_mfma_f32_32x32x16_bf16 v[32:47], a[4:7], v[196:199], v[32:47]
    v_cvt_pk_bf16_f32 v204, v88, v89
    v_cvt_pk_bf16_f32 v205, v90, v91
    v_cvt_pk_bf16_f32 v206, v92, v93
    v_cvt_pk_bf16_f32 v207, v94, v95
    v_mfma_f32_32x32x16_bf16 v[112:127], a[60:63], v[220:223], v[112:127]
    ds_read_b64_tr_b16 a[20:21], v3 offset:21504
    ds_read_b64_tr_b16 a[22:23], v3 offset:21760
    buffer_load_dwordx4 v11, s[12:15], s83 offen lds
    s_waitcnt lgkmcnt(4)
    v_mfma_f32_32x32x16_bf16 v[32:47], a[8:11], v[200:203], v[32:47]
    v_cvt_pk_bf16_f32 v208, v96, v97
    v_cvt_pk_bf16_f32 v209, v98, v99
    v_cvt_pk_bf16_f32 v210, v100, v101
    v_cvt_pk_bf16_f32 v211, v102, v103
    v_mfma_f32_32x32x16_bf16 v[80:95], a[56:59], v[224:227], v[64:79]
    ds_read_b64_tr_b16 a[24:25], v3 offset:22528
    ds_read_b64_tr_b16 a[26:27], v3 offset:22784
    s_add_u32 m0, s82, 0
    v_mfma_f32_32x32x16_bf16 v[32:47], a[12:15], v[204:207], v[32:47]
    v_cvt_pk_bf16_f32 v212, v104, v105
    v_cvt_pk_bf16_f32 v213, v106, v107
    v_cvt_pk_bf16_f32 v214, v108, v109
    v_cvt_pk_bf16_f32 v215, v110, v111
    v_mfma_f32_32x32x16_bf16 v[80:95], a[60:63], v[228:231], v[80:95]
    ds_read_b64_tr_b16 a[28:29], v3 offset:23552
    ds_read_b64_tr_b16 a[30:31], v3 offset:23808
    buffer_load_dwordx4 v12, s[36:39], s56 offen lds
    s_waitcnt vmcnt(17)
    s_barrier
    s_waitcnt lgkmcnt(4)
    v_mfma_f32_32x32x16_bf16 v[32:47], a[16:19], v[208:211], v[32:47]
    v_cvt_pk_bf16_f32 v216, v112, v113
    v_cvt_pk_bf16_f32 v217, v114, v115
    v_cvt_pk_bf16_f32 v218, v116, v117
    v_cvt_pk_bf16_f32 v219, v118, v119
    v_mfma_f32_32x32x16_bf16 v[96:111], a[56:59], v[232:235], v[64:79]
    ds_read_b64_tr_b16 a[0:1], v3 offset:24576
    ds_read_b64_tr_b16 a[2:3], v3 offset:24832
    v_mfma_f32_32x32x16_bf16 v[32:47], a[20:23], v[212:215], v[32:47]
    v_cvt_pk_bf16_f32 v220, v120, v121
    v_cvt_pk_bf16_f32 v221, v122, v123
    v_cvt_pk_bf16_f32 v222, v124, v125
    v_cvt_pk_bf16_f32 v223, v126, v127
    v_mfma_f32_32x32x16_bf16 v[96:111], a[60:63], v[236:239], v[96:111]
    ds_read_b64_tr_b16 a[4:5], v3 offset:25600
    ds_read_b64_tr_b16 a[6:7], v3 offset:25856
    buffer_load_dwordx4 v0, s[36:39], s56 offen offset:1024 lds
    s_waitcnt lgkmcnt(4)
    v_mfma_f32_32x32x16_bf16 v[32:47], a[24:27], v[216:219], v[32:47]
    v_cvt_pk_bf16_f32 v224, v80, v81
    v_cvt_pk_bf16_f32 v225, v82, v83
    v_cvt_pk_bf16_f32 v226, v84, v85
    v_cvt_pk_bf16_f32 v227, v86, v87
    v_mfma_f32_32x32x16_bf16 v[112:127], a[56:59], v[240:243], v[64:79]
    ds_read_b64_tr_b16 a[8:9], v3 offset:26624
    ds_read_b64_tr_b16 a[10:11], v3 offset:26880
    s_add_u32 s83, s56, 44032
    s_add_u32 m0, s82, 8192
    v_mfma_f32_32x32x16_bf16 v[32:47], a[28:31], v[220:223], v[32:47]
    v_cvt_pk_bf16_f32 v228, v88, v89
    v_cvt_pk_bf16_f32 v229, v90, v91
    v_cvt_pk_bf16_f32 v230, v92, v93
    v_cvt_pk_bf16_f32 v231, v94, v95
    v_mfma_f32_32x32x16_bf16 v[112:127], a[60:63], v[244:247], v[112:127]
    ds_read_b64_tr_b16 a[12:13], v3 offset:27648
    ds_read_b64_tr_b16 a[14:15], v3 offset:27904
    buffer_load_dwordx4 v12, s[36:39], s83 offen lds
    s_waitcnt lgkmcnt(4)
    v_mfma_f32_32x32x16_bf16 v[32:47], a[0:3], v[224:227], v[32:47]
    v_cvt_pk_bf16_f32 v232, v96, v97
    v_cvt_pk_bf16_f32 v233, v98, v99
    v_cvt_pk_bf16_f32 v234, v100, v101
    v_cvt_pk_bf16_f32 v235, v102, v103
    v_mfma_f32_32x32x16_bf16 v[80:95], a[56:59], v[248:251], v[64:79]
    ds_read_b64_tr_b16 a[16:17], v3 offset:28672
    ds_read_b64_tr_b16 a[18:19], v3 offset:28928
    v_mfma_f32_32x32x16_bf16 v[32:47], a[4:7], v[228:231], v[32:47]
    v_cvt_pk_bf16_f32 v236, v104, v105
    v_cvt_pk_bf16_f32 v237, v106, v107
    v_cvt_pk_bf16_f32 v238, v108, v109
    v_cvt_pk_bf16_f32 v239, v110, v111
    v_mfma_f32_32x32x16_bf16 v[80:95], a[60:63], v[252:255], v[80:95]
    ds_read_b64_tr_b16 a[20:21], v3 offset:29696
    ds_read_b64_tr_b16 a[22:23], v3 offset:29952
    buffer_load_dwordx4 v0, s[36:39], s83 offen offset:1024 lds
    s_waitcnt lgkmcnt(4)
    v_mfma_f32_32x32x16_bf16 v[32:47], a[8:11], v[232:235], v[32:47]
    v_cvt_pk_bf16_f32 v240, v112, v113
    v_cvt_pk_bf16_f32 v241, v114, v115
    v_cvt_pk_bf16_f32 v242, v116, v117
    v_cvt_pk_bf16_f32 v243, v118, v119
    ds_read_b64_tr_b16 a[24:25], v3 offset:30720
    ds_read_b64_tr_b16 a[26:27], v3 offset:30976
    s_add_u32 s83, s56, 88064
    s_add_u32 m0, s82, 16384
    v_mfma_f32_32x32x16_bf16 v[32:47], a[12:15], v[236:239], v[32:47]
    v_cvt_pk_bf16_f32 v244, v120, v121
    v_cvt_pk_bf16_f32 v245, v122, v123
    v_cvt_pk_bf16_f32 v246, v124, v125
    v_cvt_pk_bf16_f32 v247, v126, v127
    ds_read_b64_tr_b16 a[28:29], v3 offset:31744
    ds_read_b64_tr_b16 a[30:31], v3 offset:32000
    buffer_load_dwordx4 v12, s[36:39], s83 offen lds
    s_waitcnt lgkmcnt(4)
    v_mfma_f32_32x32x16_bf16 v[32:47], a[16:19], v[240:243], v[32:47]
    v_cvt_pk_bf16_f32 v248, v80, v81
    v_cvt_pk_bf16_f32 v249, v82, v83
    v_cvt_pk_bf16_f32 v250, v84, v85
    v_cvt_pk_bf16_f32 v251, v86, v87
    v_mfma_f32_32x32x16_bf16 v[32:47], a[20:23], v[244:247], v[32:47]
    v_cvt_pk_bf16_f32 v252, v88, v89
    v_cvt_pk_bf16_f32 v253, v90, v91
    v_cvt_pk_bf16_f32 v254, v92, v93
    v_cvt_pk_bf16_f32 v255, v94, v95
    buffer_load_dwordx4 v0, s[36:39], s83 offen offset:1024 lds
    s_waitcnt lgkmcnt(0)
    v_mfma_f32_32x32x16_bf16 v[32:47], a[24:27], v[248:251], v[32:47]
    s_add_u32 s83, s56, 132096
    s_add_u32 m0, s82, 24576
    v_mfma_f32_32x32x16_bf16 v[32:47], a[28:31], v[252:255], v[32:47]
    buffer_load_dwordx4 v12, s[36:39], s83 offen lds
    s_waitcnt vmcnt(15)
    s_barrier
    ds_read_b64_tr_b16 a[0:1], v3 offset:32768
    ds_read_b64_tr_b16 a[2:3], v3 offset:33024
    ds_read_b64_tr_b16 a[4:5], v3 offset:33792
    ds_read_b64_tr_b16 a[6:7], v3 offset:34048
    ds_read_b64_tr_b16 a[8:9], v3 offset:34816
    ds_read_b64_tr_b16 a[10:11], v3 offset:35072
    ds_read_b64_tr_b16 a[12:13], v3 offset:35840
    ds_read_b64_tr_b16 a[14:15], v3 offset:36096
    ds_read_b64_tr_b16 a[16:17], v3 offset:36864
    ds_read_b64_tr_b16 a[18:19], v3 offset:37120
    s_waitcnt lgkmcnt(6)
    v_mfma_f32_32x32x16_bf16 v[48:63], a[0:3], v[128:131], 0
    ds_read_b64_tr_b16 a[20:21], v3 offset:37888
    ds_read_b64_tr_b16 a[22:23], v3 offset:38144
    v_cvt_pk_bf16_f32 v18, v32, v33
    v_cvt_pk_bf16_f32 v19, v34, v35
    v_cvt_pk_bf16_f32 v20, v36, v37
    v_cvt_pk_bf16_f32 v21, v38, v39
    v_mfma_f32_32x32x16_bf16 v[48:63], a[4:7], v[132:135], v[48:63]
    ds_read_b64_tr_b16 a[24:25], v3 offset:38912
    ds_read_b64_tr_b16 a[26:27], v3 offset:39168
    buffer_load_dwordx4 v0, s[36:39], s83 offen offset:1024 lds
    v_cvt_pk_bf16_f32 v22, v40, v41
    s_waitcnt lgkmcnt(6)
    v_mfma_f32_32x32x16_bf16 v[48:63], a[8:11], v[136:139], v[48:63]
    ds_read_b64_tr_b16 a[28:29], v3 offset:39936
    ds_read_b64_tr_b16 a[30:31], v3 offset:40192
    v_cvt_pk_bf16_f32 v23, v42, v43
    v_cvt_pk_bf16_f32 v24, v44, v45
    v_cvt_pk_bf16_f32 v25, v46, v47
    v_mfma_f32_32x32x16_bf16 v[64:79], a[48:51], v[18:21], 0
    v_mfma_f32_32x32x16_bf16 v[48:63], a[12:15], v[140:143], v[48:63]
    ds_read_b64_tr_b16 a[0:1], v3 offset:40960
    ds_read_b64_tr_b16 a[2:3], v3 offset:41216
    s_add_u32 m0, s82, 32768
    v_mfma_f32_32x32x16_bf16 v[64:79], a[52:55], v[22:25], v[64:79]
    s_waitcnt lgkmcnt(6)
    v_mfma_f32_32x32x16_bf16 v[48:63], a[16:19], v[144:147], v[48:63]
    ds_read_b64_tr_b16 a[4:5], v3 offset:41984
    ds_read_b64_tr_b16 a[6:7], v3 offset:42240
    v_and_b32 v18, 31, v1
    s_lshl_b32 s76, s68, 5
    v_add_u32 v18, s76, v18
    v_lshlrev_b32 v18, 6, v18
    v_mfma_f32_32x32x16_bf16 v[48:63], a[20:23], v[148:151], v[48:63]
    ds_read_b64_tr_b16 a[8:9], v3 offset:43008
    ds_read_b64_tr_b16 a[10:11], v3 offset:43264
    buffer_load_dwordx4 v12, s[36:39], s57 offen lds
    v_bfe_u32 v19, v1, 1, 2
    s_waitcnt lgkmcnt(6)
    v_mfma_f32_32x32x16_bf16 v[48:63], a[24:27], v[152:155], v[48:63]
    ds_read_b64_tr_b16 a[12:13], v3 offset:44032
    ds_read_b64_tr_b16 a[14:15], v3 offset:44288
    v_lshl_add_u32 v18, v19, 4, v18
    v_lshrrev_b32 v19, 5, v1
    v_lshl_add_u32 v20, v19, 13, v18
    v_lshlrev_b32 v19, 4, v19
    v_mfma_f32_32x32x16_bf16 v[48:63], a[28:31], v[156:159], v[48:63]
    ds_read_b64_tr_b16 a[16:17], v3 offset:45056
    ds_read_b64_tr_b16 a[18:19], v3 offset:45312
    buffer_load_dwordx4 v0, s[36:39], s57 offen offset:1024 lds
    v_xor_b32 v21, v19, v18
    s_waitcnt lgkmcnt(6)
    v_mfma_f32_32x32x16_bf16 v[48:63], a[0:3], v[160:163], v[48:63]
    ds_read_b64_tr_b16 a[20:21], v3 offset:46080
    ds_read_b64_tr_b16 a[22:23], v3 offset:46336
    v_max3_f32 v26, v64, v65, v66
    v_min3_f32 v27, v64, v65, v66
    v_max3_f32 v26, v26, v67, v68
    v_min3_f32 v27, v27, v67, v68
    v_mfma_f32_32x32x16_bf16 v[48:63], a[4:7], v[164:167], v[48:63]
    ds_read_b64_tr_b16 a[24:25], v3 offset:47104
    ds_read_b64_tr_b16 a[26:27], v3 offset:47360
    s_add_u32 s83, s57, 44032
    s_add_u32 m0, s82, 40960
    v_max3_f32 v26, v26, v69, v70
    s_waitcnt lgkmcnt(6)
    v_mfma_f32_32x32x16_bf16 v[48:63], a[8:11], v[168:171], v[48:63]
    ds_read_b64_tr_b16 a[28:29], v3 offset:48128
    ds_read_b64_tr_b16 a[30:31], v3 offset:48384
    v_min3_f32 v27, v27, v69, v70
    v_max3_f32 v26, v26, v71, v72
    v_min3_f32 v27, v27, v71, v72
    v_max3_f32 v26, v26, v73, v74
    v_mfma_f32_32x32x16_bf16 v[48:63], a[12:15], v[172:175], v[48:63]
    ds_read_b64_tr_b16 a[0:1], v3 offset:49152
    ds_read_b64_tr_b16 a[2:3], v3 offset:49408
    buffer_load_dwordx4 v12, s[36:39], s83 offen lds
    v_min3_f32 v27, v27, v73, v74
    s_waitcnt lgkmcnt(6)
    v_mfma_f32_32x32x16_bf16 v[48:63], a[16:19], v[176:179], v[48:63]
    ds_read_b64_tr_b16 a[4:5], v3 offset:50176
    ds_read_b64_tr_b16 a[6:7], v3 offset:50432
    v_max3_f32 v26, v26, v75, v76
    v_min3_f32 v27, v27, v75, v76
    v_max3_f32 v26, v26, v77, v78
    v_min3_f32 v27, v27, v77, v78
    v_mfma_f32_32x32x16_bf16 v[48:63], a[20:23], v[180:183], v[48:63]
    ds_read_b64_tr_b16 a[8:9], v3 offset:51200
    ds_read_b64_tr_b16 a[10:11], v3 offset:51456
    buffer_load_dwordx4 v0, s[36:39], s83 offen offset:1024 lds
    v_max_f32 v26, v26, v79
    s_waitcnt lgkmcnt(6)
    v_mfma_f32_32x32x16_bf16 v[48:63], a[24:27], v[184:187], v[48:63]
    ds_read_b64_tr_b16 a[12:13], v3 offset:52224
    ds_read_b64_tr_b16 a[14:15], v3 offset:52480
    v_min_f32 v27, v27, v79
    v_mul_f32 v26, v15, v26
    v_mul_f32 v27, v15, v27
    v_fma_f32 v80, v64, v15, -v26
    v_mfma_f32_32x32x16_bf16 v[48:63], a[28:31], v[188:191], v[48:63]
    ds_read_b64_tr_b16 a[16:17], v3 offset:53248
    ds_read_b64_tr_b16 a[18:19], v3 offset:53504
    v_fma_f32 v96, -v64, v15, v27
    v_fma_f32 v81, v65, v15, -v26
    v_fma_f32 v97, -v65, v15, v27
    v_fma_f32 v82, v66, v15, -v26
    s_waitcnt lgkmcnt(6)
    v_mfma_f32_32x32x16_bf16 v[48:63], a[0:3], v[192:195], v[48:63]
    ds_read_b64_tr_b16 a[20:21], v3 offset:54272
    ds_read_b64_tr_b16 a[22:23], v3 offset:54528
    v_fma_f32 v98, -v66, v15, v27
    v_fma_f32 v83, v67, v15, -v26
    v_fma_f32 v99, -v67, v15, v27
    v_fma_f32 v84, v68, v15, -v26
    v_mfma_f32_32x32x16_bf16 v[48:63], a[4:7], v[196:199], v[48:63]
    ds_read_b64_tr_b16 a[24:25], v3 offset:55296
    ds_read_b64_tr_b16 a[26:27], v3 offset:55552
    v_fma_f32 v100, -v68, v15, v27
    v_fma_f32 v85, v69, v15, -v26
    v_fma_f32 v101, -v69, v15, v27
    v_fma_f32 v86, v70, v15, -v26
    s_waitcnt lgkmcnt(6)
    v_mfma_f32_32x32x16_bf16 v[48:63], a[8:11], v[200:203], v[48:63]
    ds_read_b64_tr_b16 a[28:29], v3 offset:56320
    ds_read_b64_tr_b16 a[30:31], v3 offset:56576
    v_fma_f32 v102, -v70, v15, v27
    v_fma_f32 v87, v71, v15, -v26
    v_fma_f32 v103, -v71, v15, v27
    v_fma_f32 v88, v72, v15, -v26
    v_mfma_f32_32x32x16_bf16 v[48:63], a[12:15], v[204:207], v[48:63]
    ds_read_b64_tr_b16 a[0:1], v3 offset:57344
    ds_read_b64_tr_b16 a[2:3], v3 offset:57600
    v_fma_f32 v104, -v72, v15, v27
    v_fma_f32 v89, v73, v15, -v26
    v_fma_f32 v105, -v73, v15, v27
    v_fma_f32 v90, v74, v15, -v26
    s_waitcnt lgkmcnt(6)
    v_mfma_f32_32x32x16_bf16 v[48:63], a[16:19], v[208:211], v[48:63]
    ds_read_b64_tr_b16 a[4:5], v3 offset:58368
    ds_read_b64_tr_b16 a[6:7], v3 offset:58624
    v_fma_f32 v106, -v74, v15, v27
    v_fma_f32 v91, v75, v15, -v26
    v_fma_f32 v107, -v75, v15, v27
    v_fma_f32 v92, v76, v15, -v26
    v_mfma_f32_32x32x16_bf16 v[48:63], a[20:23], v[212:215], v[48:63]
    ds_read_b64_tr_b16 a[8:9], v3 offset:59392
    ds_read_b64_tr_b16 a[10:11], v3 offset:59648
    v_fma_f32 v108, -v76, v15, v27
    v_fma_f32 v93, v77, v15, -v26
    v_fma_f32 v109, -v77, v15, v27
    v_fma_f32 v94, v78, v15, -v26
    s_waitcnt lgkmcnt(6)
    v_mfma_f32_32x32x16_bf16 v[48:63], a[24:27], v[216:219], v[48:63]
    ds_read_b64_tr_b16 a[12:13], v3 offset:60416
    ds_read_b64_tr_b16 a[14:15], v3 offset:60672
    v_fma_f32 v110, -v78, v15, v27
    v_fma_f32 v95, v79, v15, -v26
    v_fma_f32 v111, -v79, v15, v27
    v_exp_f32 v80, v80
    v_mfma_f32_32x32x16_bf16 v[48:63], a[28:31], v[220:223], v[48:63]
    ds_read_b64_tr_b16 a[16:17], v3 offset:61440
    ds_read_b64_tr_b16 a[18:19], v3 offset:61696
    v_exp_f32 v96, v96
    v_exp_f32 v81, v81
    s_waitcnt lgkmcnt(6)
    v_mfma_f32_32x32x16_bf16 v[48:63], a[0:3], v[224:227], v[48:63]
    ds_read_b64_tr_b16 a[20:21], v3 offset:62464
    ds_read_b64_tr_b16 a[22:23], v3 offset:62720
    v_exp_f32 v97, v97
    v_exp_f32 v82, v82
    v_mfma_f32_32x32x16_bf16 v[48:63], a[4:7], v[228:231], v[48:63]
    ds_read_b64_tr_b16 a[24:25], v3 offset:63488
    ds_read_b64_tr_b16 a[26:27], v3 offset:63744
    v_exp_f32 v98, v98
    v_exp_f32 v83, v83
    s_waitcnt lgkmcnt(6)
    v_mfma_f32_32x32x16_bf16 v[48:63], a[8:11], v[232:235], v[48:63]
    ds_read_b64_tr_b16 a[28:29], v3 offset:64512
    ds_read_b64_tr_b16 a[30:31], v3 offset:64768
    v_exp_f32 v99, v99
    v_exp_f32 v84, v84
    v_mfma_f32_32x32x16_bf16 v[48:63], a[12:15], v[236:239], v[48:63]
    v_exp_f32 v100, v100
    v_exp_f32 v85, v85
    s_waitcnt lgkmcnt(4)
    v_mfma_f32_32x32x16_bf16 v[48:63], a[16:19], v[240:243], v[48:63]
    v_exp_f32 v101, v101
    v_exp_f32 v86, v86
    v_mfma_f32_32x32x16_bf16 v[48:63], a[20:23], v[244:247], v[48:63]
    v_exp_f32 v102, v102
    v_exp_f32 v87, v87
    s_waitcnt lgkmcnt(0)
    v_mfma_f32_32x32x16_bf16 v[48:63], a[24:27], v[248:251], v[48:63]
    v_exp_f32 v103, v103
    v_exp_f32 v88, v88
    v_mfma_f32_32x32x16_bf16 v[48:63], a[28:31], v[252:255], v[48:63]
    v_exp_f32 v104, v104
    v_exp_f32 v89, v89
    s_waitcnt vmcnt(12)
    s_barrier
    ds_read_b64_tr_b16 a[0:1], v4 offset:0
    ds_read_b64_tr_b16 a[2:3], v4 offset:256
    ds_read_b64_tr_b16 a[4:5], v4 offset:1024
    ds_read_b64_tr_b16 a[6:7], v4 offset:1280
    ds_read_b64_tr_b16 a[8:9], v4 offset:2048
    ds_read_b64_tr_b16 a[10:11], v4 offset:2304
    ds_read_b64_tr_b16 a[12:13], v4 offset:3072
    ds_read_b64_tr_b16 a[14:15], v4 offset:3328
    ds_read_b64_tr_b16 a[16:17], v4 offset:4096
    ds_read_b64_tr_b16 a[18:19], v4 offset:4352
    s_waitcnt lgkmcnt(6)
    v_mfma_f32_32x32x16_bf16 v[112:127], a[0:3], v[128:131], 0
    ds_read_b64_tr_b16 a[20:21], v4 offset:5120
    ds_read_b64_tr_b16 a[22:23], v4 offset:5376
    v_exp_f32 v105, v105
    v_exp_f32 v90, v90
    v_mfma_f32_32x32x16_bf16 v[112:127], a[4:7], v[132:135], v[112:127]
    ds_read_b64_tr_b16 a[24:25], v4 offset:6144
    ds_read_b64_tr_b16 a[26:27], v4 offset:6400
    v_exp_f32 v106, v106
    v_exp_f32 v91, v91
    s_waitcnt lgkmcnt(6)
    v_mfma_f32_32x32x16_bf16 v[112:127], a[8:11], v[136:139], v[112:127]
    ds_read_b64_tr_b16 a[28:29], v4 offset:7168
    ds_read_b64_tr_b16 a[30:31], v4 offset:7424
    v_exp_f32 v107, v107
    v_exp_f32 v92, v92
    v_mfma_f32_32x32x16_bf16 v[112:127], a[12:15], v[140:143], v[112:127]
    ds_read_b64_tr_b16 a[0:1], v4 offset:8192
    ds_read_b64_tr_b16 a[2:3], v4 offset:8448
    v_exp_f32 v108, v108
    v_exp_f32 v93, v93
    s_waitcnt lgkmcnt(6)
    v_mfma_f32_32x32x16_bf16 v[112:127], a[16:19], v[144:147], v[112:127]
    ds_read_b64_tr_b16 a[4:5], v4 offset:9216
    ds_read_b64_tr_b16 a[6:7], v4 offset:9472
    v_exp_f32 v109, v109
    v_exp_f32 v94, v94
    v_mfma_f32_32x32x16_bf16 v[112:127], a[20:23], v[148:151], v[112:127]
    ds_read_b64_tr_b16 a[8:9], v4 offset:10240
    ds_read_b64_tr_b16 a[10:11], v4 offset:10496
    v_exp_f32 v110, v110
    v_exp_f32 v95, v95
    s_waitcnt lgkmcnt(6)
    v_mfma_f32_32x32x16_bf16 v[112:127], a[24:27], v[152:155], v[112:127]
    ds_read_b64_tr_b16 a[12:13], v4 offset:11264
    ds_read_b64_tr_b16 a[14:15], v4 offset:11520
    v_exp_f32 v111, v111
    v_add_f32 v28, v80, v81
    v_add_f32 v29, v96, v97
    v_mfma_f32_32x32x16_bf16 v[112:127], a[28:31], v[156:159], v[112:127]
    ds_read_b64_tr_b16 a[16:17], v4 offset:12288
    ds_read_b64_tr_b16 a[18:19], v4 offset:12544
    v_add_f32 v28, v28, v82
    v_add_f32 v29, v29, v98
    v_add_f32 v28, v28, v83
    v_add_f32 v29, v29, v99
    s_waitcnt lgkmcnt(6)
    v_mfma_f32_32x32x16_bf16 v[112:127], a[0:3], v[160:163], v[112:127]
    ds_read_b64_tr_b16 a[20:21], v4 offset:13312
    ds_read_b64_tr_b16 a[22:23], v4 offset:13568
    v_add_f32 v28, v28, v84
    v_add_f32 v29, v29, v100
    v_add_f32 v28, v28, v85
    v_add_f32 v29, v29, v101
    v_mfma_f32_32x32x16_bf16 v[112:127], a[4:7], v[164:167], v[112:127]
    ds_read_b64_tr_b16 a[24:25], v4 offset:14336
    ds_read_b64_tr_b16 a[26:27], v4 offset:14592
    v_add_f32 v28, v28, v86
    v_add_f32 v29, v29, v102
    v_add_f32 v28, v28, v87
    v_add_f32 v29, v29, v103
    s_waitcnt lgkmcnt(6)
    v_mfma_f32_32x32x16_bf16 v[112:127], a[8:11], v[168:171], v[112:127]
    ds_read_b64_tr_b16 a[28:29], v4 offset:15360
    ds_read_b64_tr_b16 a[30:31], v4 offset:15616
    v_add_f32 v28, v28, v88
    v_add_f32 v29, v29, v104
    v_add_f32 v28, v28, v89
    v_add_f32 v29, v29, v105
    v_mfma_f32_32x32x16_bf16 v[112:127], a[12:15], v[172:175], v[112:127]
    ds_read_b64_tr_b16 a[0:1], v4 offset:16384
    ds_read_b64_tr_b16 a[2:3], v4 offset:16640
    v_add_f32 v28, v28, v90
    v_add_f32 v29, v29, v106
    v_add_f32 v28, v28, v91
    v_add_f32 v29, v29, v107
    s_waitcnt lgkmcnt(6)
    v_mfma_f32_32x32x16_bf16 v[112:127], a[16:19], v[176:179], v[112:127]
    ds_read_b64_tr_b16 a[4:5], v4 offset:17408
    ds_read_b64_tr_b16 a[6:7], v4 offset:17664
    v_add_f32 v28, v28, v92
    v_add_f32 v29, v29, v108
    v_add_f32 v28, v28, v93
    v_add_f32 v29, v29, v109
    v_mfma_f32_32x32x16_bf16 v[112:127], a[20:23], v[180:183], v[112:127]
    ds_read_b64_tr_b16 a[8:9], v4 offset:18432
    ds_read_b64_tr_b16 a[10:11], v4 offset:18688
    v_add_f32 v28, v28, v94
    v_add_f32 v29, v29, v110
    v_add_f32 v28, v28, v95
    v_add_f32 v29, v29, v111
    s_waitcnt lgkmcnt(6)
    v_mfma_f32_32x32x16_bf16 v[112:127], a[24:27], v[184:187], v[112:127]
    ds_read_b64_tr_b16 a[12:13], v4 offset:19456
    ds_read_b64_tr_b16 a[14:15], v4 offset:19712
    v_rcp_f32 v28, v28
    v_rcp_f32 v29, v29
    v_mfma_f32_32x32x16_bf16 v[112:127], a[28:31], v[188:191], v[112:127]
    ds_read_b64_tr_b16 a[16:17], v4 offset:20480
    ds_read_b64_tr_b16 a[18:19], v4 offset:20736
    v_mul_f32 v80, v80, v28
    v_mul_f32 v96, v96, v29
    v_mul_f32 v81, v81, v28
    v_mul_f32 v97, v97, v29
    s_waitcnt lgkmcnt(6)
    v_mfma_f32_32x32x16_bf16 v[112:127], a[0:3], v[192:195], v[112:127]
    ds_read_b64_tr_b16 a[20:21], v4 offset:21504
    ds_read_b64_tr_b16 a[22:23], v4 offset:21760
    v_mul_f32 v82, v82, v28
    v_mul_f32 v98, v98, v29
    v_mul_f32 v83, v83, v28
    v_mul_f32 v99, v99, v29
    v_mfma_f32_32x32x16_bf16 v[112:127], a[4:7], v[196:199], v[112:127]
    ds_read_b64_tr_b16 a[24:25], v4 offset:22528
    ds_read_b64_tr_b16 a[26:27], v4 offset:22784
    v_mul_f32 v84, v84, v28
    v_mul_f32 v100, v100, v29
    v_mul_f32 v85, v85, v28
    v_mul_f32 v101, v101, v29
    s_waitcnt lgkmcnt(6)
    v_mfma_f32_32x32x16_bf16 v[112:127], a[8:11], v[200:203], v[112:127]
    ds_read_b64_tr_b16 a[28:29], v4 offset:23552
    ds_read_b64_tr_b16 a[30:31], v4 offset:23808
    v_mul_f32 v86, v86, v28
    v_mul_f32 v102, v102, v29
    v_mul_f32 v87, v87, v28
    v_mul_f32 v103, v103, v29
    v_mfma_f32_32x32x16_bf16 v[112:127], a[12:15], v[204:207], v[112:127]
    ds_read_b64_tr_b16 a[0:1], v4 offset:24576
    ds_read_b64_tr_b16 a[2:3], v4 offset:24832
    v_mul_f32 v88, v88, v28
    v_mul_f32 v104, v104, v29
    v_mul_f32 v89, v89, v28
    v_mul_f32 v105, v105, v29
    s_waitcnt lgkmcnt(6)
    v_mfma_f32_32x32x16_bf16 v[112:127], a[16:19], v[208:211], v[112:127]
    ds_read_b64_tr_b16 a[4:5], v4 offset:25600
    ds_read_b64_tr_b16 a[6:7], v4 offset:25856
    v_mul_f32 v90, v90, v28
    v_mul_f32 v106, v106, v29
    v_mul_f32 v91, v91, v28
    v_mul_f32 v107, v107, v29
    v_mfma_f32_32x32x16_bf16 v[112:127], a[20:23], v[212:215], v[112:127]
    ds_read_b64_tr_b16 a[8:9], v4 offset:26624
    ds_read_b64_tr_b16 a[10:11], v4 offset:26880
    v_mul_f32 v92, v92, v28
    v_mul_f32 v108, v108, v29
    v_mul_f32 v93, v93, v28
    v_mul_f32 v109, v109, v29
    s_waitcnt lgkmcnt(6)
    v_mfma_f32_32x32x16_bf16 v[112:127], a[24:27], v[216:219], v[112:127]
    ds_read_b64_tr_b16 a[12:13], v4 offset:27648
    ds_read_b64_tr_b16 a[14:15], v4 offset:27904
    v_mul_f32 v94, v94, v28
    v_mul_f32 v110, v110, v29
    v_mul_f32 v95, v95, v28
    v_mul_f32 v111, v111, v29
    v_mfma_f32_32x32x16_bf16 v[112:127], a[28:31], v[220:223], v[112:127]
    ds_read_b64_tr_b16 a[16:17], v4 offset:28672
    ds_read_b64_tr_b16 a[18:19], v4 offset:28928
    v_cvt_pk_bf16_f32 v64, v80, v81
    v_cvt_pk_bf16_f32 v65, v82, v83
    v_cvt_pk_bf16_f32 v66, v88, v89
    v_cvt_pk_bf16_f32 v67, v90, v91
    s_waitcnt lgkmcnt(6)
    v_mfma_f32_32x32x16_bf16 v[112:127], a[0:3], v[224:227], v[112:127]
    ds_read_b64_tr_b16 a[20:21], v4 offset:29696
    ds_read_b64_tr_b16 a[22:23], v4 offset:29952
    v_cvt_pk_bf16_f32 v68, v84, v85
    v_cvt_pk_bf16_f32 v69, v86, v87
    v_cvt_pk_bf16_f32 v70, v92, v93
    v_cvt_pk_bf16_f32 v71, v94, v95
    v_mfma_f32_32x32x16_bf16 v[112:127], a[4:7], v[228:231], v[112:127]
    ds_read_b64_tr_b16 a[24:25], v4 offset:30720
    ds_read_b64_tr_b16 a[26:27], v4 offset:30976
    v_cvt_pk_bf16_f32 v72, v96, v97
    v_cvt_pk_bf16_f32 v73, v98, v99
    v_cvt_pk_bf16_f32 v74, v104, v105
    v_cvt_pk_bf16_f32 v75, v106, v107
    s_waitcnt lgkmcnt(6)
    v_mfma_f32_32x32x16_bf16 v[112:127], a[8:11], v[232:235], v[112:127]
    ds_read_b64_tr_b16 a[28:29], v4 offset:31744
    ds_read_b64_tr_b16 a[30:31], v4 offset:32000
    v_cvt_pk_bf16_f32 v76, v100, v101
    v_cvt_pk_bf16_f32 v77, v102, v103
    v_cvt_pk_bf16_f32 v78, v108, v109
    v_cvt_pk_bf16_f32 v79, v110, v111
    v_mfma_f32_32x32x16_bf16 v[112:127], a[12:15], v[236:239], v[112:127]
    ds_write_b128 v20, v[64:67] offset:0
    v_xor_b32 v22, 16, v20
    ds_write_b128 v22, v[68:71] offset:0
    v_xor_b32 v22, 32, v20
    s_waitcnt lgkmcnt(6)
    v_mfma_f32_32x32x16_bf16 v[112:127], a[16:19], v[240:243], v[112:127]
    ds_write_b128 v22, v[72:75] offset:0
    v_xor_b32 v22, 48, v20
    ds_write_b128 v22, v[76:79] offset:0
    v_mul_f32 v48, v48, v17
    v_mfma_f32_32x32x16_bf16 v[112:127], a[20:23], v[244:247], v[112:127]
    v_mul_f32 v49, v49, v17
    v_mul_f32 v50, v50, v17
    v_mul_f32 v51, v51, v17
    v_mul_f32 v52, v52, v17
    s_waitcnt lgkmcnt(4)
    v_mfma_f32_32x32x16_bf16 v[112:127], a[24:27], v[248:251], v[112:127]
    v_mul_f32 v53, v53, v17
    v_mul_f32 v54, v54, v17
    v_mul_f32 v55, v55, v17
    v_mul_f32 v56, v56, v17
    v_mfma_f32_32x32x16_bf16 v[112:127], a[28:31], v[252:255], v[112:127]
    v_mul_f32 v57, v57, v17
    v_mul_f32 v58, v58, v17
    v_mul_f32 v59, v59, v17
    v_mul_f32 v60, v60, v17
    v_mul_f32 v61, v61, v17
    v_mul_f32 v62, v62, v17
    v_mul_f32 v63, v63, v17
    v_cvt_pk_bf16_f32 v80, v48, v49
    v_cvt_pk_bf16_f32 v81, v50, v51
    v_cvt_pk_bf16_f32 v82, v52, v53
    v_cvt_pk_bf16_f32 v83, v54, v55
    v_cvt_pk_bf16_f32 v84, v56, v57
    v_cvt_pk_bf16_f32 v85, v58, v59
    v_cvt_pk_bf16_f32 v86, v60, v61
    v_cvt_pk_bf16_f32 v87, v62, v63
    v_mov_b32 v88, 0x3f803f80
    v_mov_b32 v89, 0x3f803f80
    v_mov_b32 v90, 0x3f803f80
    v_mov_b32 v91, 0x3f803f80
    v_xor_b32 v22, 32, v21
    ds_write_b128 v21, v[80:83] offset:16384
    ds_write_b128 v21, v[84:87] offset:24576
    ds_write_b128 v22, v[88:91] offset:16384
    ds_write_b128 v22, v[88:91] offset:24576
    s_waitcnt lgkmcnt(0)
    s_barrier
    v_cvt_pk_bf16_f32 v18, v112, v113
    v_cvt_pk_bf16_f32 v19, v114, v115
    v_cvt_pk_bf16_f32 v20, v116, v117
    v_cvt_pk_bf16_f32 v21, v118, v119
    v_cvt_pk_bf16_f32 v22, v120, v121
    v_cvt_pk_bf16_f32 v23, v122, v123
    v_cvt_pk_bf16_f32 v24, v124, v125
    v_cvt_pk_bf16_f32 v25, v126, v127
    v_accvgpr_write_b32 a64, v18
    v_accvgpr_write_b32 a65, v19
    v_accvgpr_write_b32 a66, v20
    v_accvgpr_write_b32 a67, v21
    v_accvgpr_write_b32 a68, v22
    v_accvgpr_write_b32 a69, v23
    v_accvgpr_write_b32 a70, v24
    v_accvgpr_write_b32 a71, v25
    s_waitcnt vmcnt(6)
    s_barrier
    ds_read_b64_tr_b16 a[0:1], v5 offset:0
    ds_read_b64_tr_b16 a[2:3], v5 offset:1024
    ds_read_b64_tr_b16 a[4:5], v6 offset:0
    ds_read_b64_tr_b16 a[6:7], v6 offset:1024
    ds_read_b64_tr_b16 a[8:9], v7 offset:0
    ds_read_b64_tr_b16 a[10:11], v7 offset:1024
    ds_read_b64_tr_b16 a[12:13], v8 offset:0
    ds_read_b64_tr_b16 a[14:15], v8 offset:1024
    ds_read_b64_tr_b16 a[16:17], v9 offset:0
    ds_read_b64_tr_b16 a[18:19], v9 offset:1024
    ds_read_b64_tr_b16 a[20:21], v10 offset:0
    ds_read_b64_tr_b16 a[22:23], v10 offset:1024
    s_waitcnt lgkmcnt(6)
    v_mfma_f32_32x32x16_bf16 v[32:47], a[0:3], v[128:131], 0
    ds_read_b64_tr_b16 a[24:25], v5 offset:8192
    ds_read_b64_tr_b16 a[26:27], v5 offset:9216
    s_add_u32 s83, s57, 88064
    s_add_u32 m0, s82, 49152
    s_and_b32 s76, s68, 1
    s_lshl_b32 s76, s76, 13
    v_bfe_u32 v19, v1, 3, 1
    v_lshlrev_b32 v19, 4, v19
    v_mfma_f32_32x32x16_bf16 v[48:63], a[4:7], v[128:131], 0
    ds_read_b64_tr_b16 a[28:29], v6 offset:8192
    ds_read_b64_tr_b16 a[30:31], v6 offset:9216
    buffer_load_dwordx4 v12, s[36:39], s83 offen lds
    v_xor_b32 v18, v19, v3
    v_add_u32 v18, s76, v18
    v_xor_b32 v19, 32, v18
    ds_read_b64_tr_b16 a[104:105], v18 offset:0
    v_mfma_f32_32x32x16_bf16 v[64:79], a[8:11], v[128:131], 0
    ds_read_b64_tr_b16 a[32:33], v7 offset:8192
    ds_read_b64_tr_b16 a[34:35], v7 offset:9216
    buffer_load_dwordx4 v0, s[36:39], s83 offen offset:1024 lds
    ds_read_b64_tr_b16 a[106:107], v19 offset:256
    ds_read_b64_tr_b16 a[108:109], v18 offset:16384
    ds_read_b64_tr_b16 a[110:111], v19 offset:16640
    ds_read_b64_tr_b16 a[112:113], v18 offset:1024
    s_waitcnt lgkmcnt(11)
    v_mfma_f32_32x32x16_bf16 v[80:95], a[12:15], v[128:131], 0
    ds_read_b64_tr_b16 a[36:37], v8 offset:8192
    ds_read_b64_tr_b16 a[38:39], v8 offset:9216
    ds_read_b64_tr_b16 a[114:115], v19 offset:1280
    ds_read_b64_tr_b16 a[116:117], v18 offset:17408
    ds_read_b64_tr_b16 a[118:119], v19 offset:17664
    ds_read_b64_tr_b16 a[120:121], v18 offset:2048
    v_mfma_f32_32x32x16_bf16 v[96:111], a[16:19], v[128:131], 0
    ds_read_b64_tr_b16 a[40:41], v9 offset:8192
    ds_read_b64_tr_b16 a[42:43], v9 offset:9216
    ds_read_b64_tr_b16 a[122:123], v19 offset:2304
    ds_read_b64_tr_b16 a[124:125], v18 offset:18432
    ds_read_b64_tr_b16 a[126:127], v19 offset:18688
    ds_read_b64_tr_b16 a[128:129], v18 offset:3072
    v_mfma_f32_32x32x16_bf16 v[112:127], a[20:23], v[128:131], 0
    ds_read_b64_tr_b16 a[44:45], v10 offset:8192
    ds_read_b64_tr_b16 a[46:47], v10 offset:9216
    ds_read_b64_tr_b16 a[130:131], v19 offset:3328
    ds_read_b64_tr_b16 a[132:133], v18 offset:19456
    ds_read_b64_tr_b16 a[134:135], v19 offset:19712
    ds_read_b64_tr_b16 a[136:137], v18 offset:4096
    s_waitcnt lgkmcnt(15)
    v_mfma_f32_32x32x16_bf16 v[32:47], a[24:27], v[132:135], v[32:47]
    ds_read_b64_tr_b16 a[0:1], v5 offset:16384
    ds_read_b64_tr_b16 a[2:3], v5 offset:17408
    s_add_u32 s83, s57, 132096
    s_add_u32 m0, s82, 57344
    ds_read_b64_tr_b16 a[138:139], v19 offset:4352
    ds_read_b64_tr_b16 a[140:141], v18 offset:20480
    ds_read_b64_tr_b16 a[142:143], v19 offset:20736
    ds_read_b64_tr_b16 a[144:145], v18 offset:5120
    v_mfma_f32_32x32x16_bf16 v[48:63], a[28:31], v[132:135], v[48:63]
    ds_read_b64_tr_b16 a[4:5], v6 offset:16384
    ds_read_b64_tr_b16 a[6:7], v6 offset:17408
    buffer_load_dwordx4 v12, s[36:39], s83 offen lds
    ds_read_b64_tr_b16 a[146:147], v19 offset:5376
    ds_read_b64_tr_b16 a[148:149], v18 offset:21504
    ds_read_b64_tr_b16 a[150:151], v19 offset:21760
    ds_read_b64_tr_b16 a[152:153], v18 offset:6144
    v_mfma_f32_32x32x16_bf16 v[64:79], a[32:35], v[132:135], v[64:79]
    ds_read_b64_tr_b16 a[8:9], v7 offset:16384
    ds_read_b64_tr_b16 a[10:11], v7 offset:17408
    buffer_load_dwordx4 v0, s[36:39], s83 offen offset:1024 lds
    ds_read_b64_tr_b16 a[154:155], v19 offset:6400
    ds_read_b64_tr_b16 a[156:157], v18 offset:22528
    ds_read_b64_tr_b16 a[158:159], v19 offset:22784
    ds_read_b64_tr_b16 a[160:161], v18 offset:7168
    s_waitcnt lgkmcnt(15)
    v_mfma_f32_32x32x16_bf16 v[80:95], a[36:39], v[132:135], v[80:95]
    ds_read_b64_tr_b16 a[12:13], v8 offset:16384
    ds_read_b64_tr_b16 a[14:15], v8 offset:17408
    ds_read_b64_tr_b16 a[162:163], v19 offset:7424
    ds_read_b64_tr_b16 a[164:165], v18 offset:23552
    ds_read_b64_tr_b16 a[166:167], v19 offset:23808
    s_lshl_b32 s76, s69, 10
    v_mfma_f32_32x32x16_bf16 v[96:111], a[40:43], v[132:135], v[96:111]
    ds_read_b64_tr_b16 a[16:17], v9 offset:16384
    ds_read_b64_tr_b16 a[18:19], v9 offset:17408
    s_add_u32 s76, s76, s95
    s_waitcnt lgkmcnt(15)
    v_mfma_f32_32x32x16_bf16 a[168:183], a[104:107], a[108:111], 0
    v_mfma_f32_32x32x16_bf16 v[112:127], a[44:47], v[132:135], v[112:127]
    ds_read_b64_tr_b16 a[20:21], v10 offset:16384
    ds_read_b64_tr_b16 a[22:23], v10 offset:17408
    v_mfma_f32_32x32x16_bf16 a[168:183], a[112:115], a[116:119], a[168:183]
    v_mfma_f32_32x32x16_bf16 a[168:183], a[120:123], a[124:127], a[168:183]
    s_waitcnt vmcnt(6)
    s_barrier
    s_waitcnt lgkmcnt(13)
    v_mfma_f32_32x32x16_bf16 v[32:47], a[0:3], v[136:139], v[32:47]
    ds_read_b64_tr_b16 a[24:25], v5 offset:24576
    ds_read_b64_tr_b16 a[26:27], v5 offset:25600
    s_add_u32 m0, s82, 0
    v_mfma_f32_32x32x16_bf16 a[168:183], a[128:131], a[132:135], a[168:183]
    s_waitcnt lgkmcnt(6)
    v_mfma_f32_32x32x16_bf16 a[168:183], a[136:139], a[140:143], a[168:183]
    v_mfma_f32_32x32x16_bf16 v[48:63], a[4:7], v[136:139], v[48:63]
    ds_read_b64_tr_b16 a[28:29], v6 offset:24576
    ds_read_b64_tr_b16 a[30:31], v6 offset:25600
    buffer_load_dwordx4 v12, s[36:39], s58 offen lds
    v_mfma_f32_32x32x16_bf16 a[168:183], a[144:147], a[148:151], a[168:183]
    v_mfma_f32_32x32x16_bf16 a[168:183], a[152:155], a[156:159], a[168:183]
    v_mfma_f32_32x32x16_bf16 v[64:79], a[8:11], v[136:139], v[64:79]
    ds_read_b64_tr_b16 a[32:33], v7 offset:24576
    ds_read_b64_tr_b16 a[34:35], v7 offset:25600
    buffer_load_dwordx4 v0, s[36:39], s58 offen offset:1024 lds
    v_mfma_f32_32x32x16_bf16 a[168:183], a[160:163], a[164:167], a[168:183]
    s_nop 9
    s_cmp_lt_u32 s68, 2
    s_cbranch_scc1 L_kvs0
    v_accvgpr_read_b32 v20, a176
    v_accvgpr_read_b32 v21, a177
    v_accvgpr_read_b32 v22, a178
    v_accvgpr_read_b32 v23, a179
    v_accvgpr_read_b32 v24, a180
    v_accvgpr_read_b32 v25, a181
    v_accvgpr_read_b32 v26, a182
    v_accvgpr_read_b32 v27, a183
    s_branch L_kvs1
L_kvs0:
    v_accvgpr_read_b32 v20, a168
    v_accvgpr_read_b32 v21, a169
    v_accvgpr_read_b32 v22, a170
    v_accvgpr_read_b32 v23, a171
    v_accvgpr_read_b32 v24, a172
    v_accvgpr_read_b32 v25, a173
    v_accvgpr_read_b32 v26, a174
    v_accvgpr_read_b32 v27, a175
L_kvs1:
    s_waitcnt lgkmcnt(6)
    v_mfma_f32_32x32x16_bf16 v[80:95], a[12:15], v[136:139], v[80:95]
    ds_read_b64_tr_b16 a[36:37], v8 offset:24576
    ds_read_b64_tr_b16 a[38:39], v8 offset:25600
    v_cvt_pk_bf16_f32 v20, v20, v21
    v_cvt_pk_bf16_f32 v21, v22, v23
    v_cvt_pk_bf16_f32 v22, v24, v25
    v_cvt_pk_bf16_f32 v23, v26, v27
    v_mfma_f32_32x32x16_bf16 v[96:111], a[16:19], v[136:139], v[96:111]
    ds_read_b64_tr_b16 a[40:41], v9 offset:24576
    ds_read_b64_tr_b16 a[42:43], v9 offset:25600
    buffer_store_dwordx4 v[20:23], v2, s[32:35], s76 offen sc1
    v_mfma_f32_32x32x16_bf16 v[112:127], a[20:23], v[136:139], v[112:127]
    ds_read_b64_tr_b16 a[44:45], v10 offset:24576
    ds_read_b64_tr_b16 a[46:47], v10 offset:25600
    s_waitcnt lgkmcnt(6)
    v_mfma_f32_32x32x16_bf16 v[32:47], a[24:27], v[140:143], v[32:47]
    ds_read_b64_tr_b16 a[0:1], v5 offset:32768
    ds_read_b64_tr_b16 a[2:3], v5 offset:33792
    s_add_u32 s83, s58, 44032
    s_add_u32 m0, s82, 8192
    v_mfma_f32_32x32x16_bf16 v[48:63], a[28:31], v[140:143], v[48:63]
    ds_read_b64_tr_b16 a[4:5], v6 offset:32768
    ds_read_b64_tr_b16 a[6:7], v6 offset:33792
    buffer_load_dwordx4 v12, s[36:39], s83 offen lds
    v_mfma_f32_32x32x16_bf16 v[64:79], a[32:35], v[140:143], v[64:79]
    ds_read_b64_tr_b16 a[8:9], v7 offset:32768
    ds_read_b64_tr_b16 a[10:11], v7 offset:33792
    buffer_load_dwordx4 v0, s[36:39], s83 offen offset:1024 lds
    s_waitcnt lgkmcnt(6)
    v_mfma_f32_32x32x16_bf16 v[80:95], a[36:39], v[140:143], v[80:95]
    ds_read_b64_tr_b16 a[12:13], v8 offset:32768
    ds_read_b64_tr_b16 a[14:15], v8 offset:33792
    v_mfma_f32_32x32x16_bf16 v[96:111], a[40:43], v[140:143], v[96:111]
    ds_read_b64_tr_b16 a[16:17], v9 offset:32768
    ds_read_b64_tr_b16 a[18:19], v9 offset:33792
    v_mfma_f32_32x32x16_bf16 v[112:127], a[44:47], v[140:143], v[112:127]
    ds_read_b64_tr_b16 a[20:21], v10 offset:32768
    ds_read_b64_tr_b16 a[22:23], v10 offset:33792
    s_waitcnt vmcnt(7)
    s_barrier
    s_waitcnt lgkmcnt(6)
    v_mfma_f32_32x32x16_bf16 v[32:47], a[0:3], v[144:147], v[32:47]
    ds_read_b64_tr_b16 a[24:25], v5 offset:40960
    ds_read_b64_tr_b16 a[26:27], v5 offset:41984
    s_add_u32 s83, s58, 88064
    s_add_u32 m0, s82, 16384
    v_mfma_f32_32x32x16_bf16 v[48:63], a[4:7], v[144:147], v[48:63]
    ds_read_b64_tr_b16 a[28:29], v6 offset:40960
    ds_read_b64_tr_b16 a[30:31], v6 offset:41984
    buffer_load_dwordx4 v12, s[36:39], s83 offen lds
    v_mfma_f32_32x32x16_bf16 v[64:79], a[8:11], v[144:147], v[64:79]
    ds_read_b64_tr_b16 a[32:33], v7 offset:40960
    ds_read_b64_tr_b16 a[34:35], v7 offset:41984
    buffer_load_dwordx4 v0, s[36:39], s83 offen offset:1024 lds
    s_waitcnt lgkmcnt(6)
    v_mfma_f32_32x32x16_bf16 v[80:95], a[12:15], v[144:147], v[80:95]
    ds_read_b64_tr_b16 a[36:37], v8 offset:40960
    ds_read_b64_tr_b16 a[38:39], v8 offset:41984
    s_add_u32 m0, s90, 0
    v_mfma_f32_32x32x16_bf16 v[96:111], a[16:19], v[144:147], v[96:111]
    ds_read_b64_tr_b16 a[40:41], v9 offset:40960
    ds_read_b64_tr_b16 a[42:43], v9 offset:41984
    buffer_load_dwordx4 v13, s[24:27], s42 offen lds
    v_mfma_f32_32x32x16_bf16 v[112:127], a[20:23], v[144:147], v[112:127]
    ds_read_b64_tr_b16 a[44:45], v10 offset:40960
    ds_read_b64_tr_b16 a[46:47], v10 offset:41984
    buffer_load_dwordx4 v14, s[24:27], s42 offen offset:1024 lds
    s_add_u32 s42, s42, 65536
    s_cmp_eq_u32 s42, s44
    s_cselect_b32 s42, s89, s42
    s_waitcnt lgkmcnt(6)
    v_mfma_f32_32x32x16_bf16 v[32:47], a[24:27], v[148:151], v[32:47]
    ds_read_b64_tr_b16 a[0:1], v5 offset:49152
    ds_read_b64_tr_b16 a[2:3], v5 offset:50176
    s_add_u32 s83, s58, 132096
    s_add_u32 m0, s82, 24576
    v_mfma_f32_32x32x16_bf16 v[48:63], a[28:31], v[148:151], v[48:63]
    ds_read_b64_tr_b16 a[4:5], v6 offset:49152
    ds_read_b64_tr_b16 a[6:7], v6 offset:50176
    buffer_load_dwordx4 v12, s[36:39], s83 offen lds
    v_mfma_f32_32x32x16_bf16 v[64:79], a[32:35], v[148:151], v[64:79]
    ds_read_b64_tr_b16 a[8:9], v7 offset:49152
    ds_read_b64_tr_b16 a[10:11], v7 offset:50176
    buffer_load_dwordx4 v0, s[36:39], s83 offen offset:1024 lds
    s_waitcnt lgkmcnt(6)
    v_mfma_f32_32x32x16_bf16 v[80:95], a[36:39], v[148:151], v[80:95]
    ds_read_b64_tr_b16 a[12:13], v8 offset:49152
    ds_read_b64_tr_b16 a[14:15], v8 offset:50176
    v_mfma_f32_32x32x16_bf16 v[96:111], a[40:43], v[148:151], v[96:111]
    ds_read_b64_tr_b16 a[16:17], v9 offset:49152
    ds_read_b64_tr_b16 a[18:19], v9 offset:50176
    v_mfma_f32_32x32x16_bf16 v[112:127], a[44:47], v[148:151], v[112:127]
    ds_read_b64_tr_b16 a[20:21], v10 offset:49152
    ds_read_b64_tr_b16 a[22:23], v10 offset:50176
    s_waitcnt vmcnt(9)
    s_barrier
    s_waitcnt lgkmcnt(6)
    v_mfma_f32_32x32x16_bf16 v[32:47], a[0:3], v[152:155], v[32:47]
    ds_read_b64_tr_b16 a[24:25], v5 offset:57344
    ds_read_b64_tr_b16 a[26:27], v5 offset:58368
    s_add_u32 m0, s82, 32768
    v_mfma_f32_32x32x16_bf16 v[48:63], a[4:7], v[152:155], v[48:63]
    ds_read_b64_tr_b16 a[28:29], v6 offset:57344
    ds_read_b64_tr_b16 a[30:31], v6 offset:58368
    buffer_load_dwordx4 v12, s[36:39], s59 offen lds
    v_mfma_f32_32x32x16_bf16 v[64:79], a[8:11], v[152:155], v[64:79]
    ds_read_b64_tr_b16 a[32:33], v7 offset:57344
    ds_read_b64_tr_b16 a[34:35], v7 offset:58368
    buffer_load_dwordx4 v0, s[36:39], s59 offen offset:1024 lds
    s_waitcnt lgkmcnt(6)
    v_mfma_f32_32x32x16_bf16 v[80:95], a[12:15], v[152:155], v[80:95]
    ds_read_b64_tr_b16 a[36:37], v8 offset:57344
    ds_read_b64_tr_b16 a[38:39], v8 offset:58368
    s_add_u32 m0, s90, 2048
    v_mfma_f32_32x32x16_bf16 v[96:111], a[16:19], v[152:155], v[96:111]
    ds_read_b64_tr_b16 a[40:41], v9 offset:57344
    ds_read_b64_tr_b16 a[42:43], v9 offset:58368
    buffer_load_dwordx4 v13, s[24:27], s42 offen lds
    v_mfma_f32_32x32x16_bf16 v[112:127], a[20:23], v[152:155], v[112:127]
    ds_read_b64_tr_b16 a[44:45], v10 offset:57344
    ds_read_b64_tr_b16 a[46:47], v10 offset:58368
    buffer_load_dwordx4 v14, s[24:27], s42 offen offset:1024 lds
    s_add_u32 s42, s42, 65536
    s_cmp_eq_u32 s42, s44
    s_cselect_b32 s42, s89, s42
    s_waitcnt lgkmcnt(6)
    v_mfma_f32_32x32x16_bf16 v[32:47], a[24:27], v[156:159], v[32:47]
    ds_read_b64_tr_b16 a[0:1], v5 offset:0
    ds_read_b64_tr_b16 a[2:3], v5 offset:1024
    s_add_u32 s83, s59, 44032
    s_add_u32 m0, s82, 40960
    v_mfma_f32_32x32x16_bf16 v[48:63], a[28:31], v[156:159], v[48:63]
    ds_read_b64_tr_b16 a[4:5], v6 offset:0
    ds_read_b64_tr_b16 a[6:7], v6 offset:1024
    buffer_load_dwordx4 v12, s[36:39], s83 offen lds
    v_mfma_f32_32x32x16_bf16 v[64:79], a[32:35], v[156:159], v[64:79]
    ds_read_b64_tr_b16 a[8:9], v7 offset:0
    ds_read_b64_tr_b16 a[10:11], v7 offset:1024
    buffer_load_dwordx4 v0, s[36:39], s83 offen offset:1024 lds
    s_waitcnt lgkmcnt(6)
    v_mfma_f32_32x32x16_bf16 v[80:95], a[36:39], v[156:159], v[80:95]
    ds_read_b64_tr_b16 a[12:13], v8 offset:0
    ds_read_b64_tr_b16 a[14:15], v8 offset:1024
    v_mfma_f32_32x32x16_bf16 v[96:111], a[40:43], v[156:159], v[96:111]
    ds_read_b64_tr_b16 a[16:17], v9 offset:0
    ds_read_b64_tr_b16 a[18:19], v9 offset:1024
    v_mfma_f32_32x32x16_bf16 v[112:127], a[44:47], v[156:159], v[112:127]
    ds_read_b64_tr_b16 a[20:21], v10 offset:0
    ds_read_b64_tr_b16 a[22:23], v10 offset:1024
    s_waitcnt vmcnt(14)
    s_waitcnt vmcnt(10)
    s_barrier
    s_waitcnt lgkmcnt(6)
    v_mfma_f32_32x32x16_bf16 v[32:47], a[0:3], v[160:163], v[32:47]
    ds_read_b64_tr_b16 a[24:25], v5 offset:8192
    ds_read_b64_tr_b16 a[26:27], v5 offset:9216
    s_add_u32 s83, s59, 88064
    s_add_u32 m0, s82, 49152
    s_cmp_lg_u32 s68, 0
    s_cbranch_scc1 L_fkv
    s_lshl_b32 s72, s70, 7
    s_lshl_b32 s73, s69, 2
    s_add_u32 s72, s72, s73
    s_add_u32 s72, s72, 4096
    v_mov_b32 v30, s71
    s_mov_b64 exec, 1
    buffer_store_dword v30, off, s[32:35], s72 sc1
    s_mov_b64 exec, -1
L_fkv:
    v_mfma_f32_32x32x16_bf16 v[48:63], a[4:7], v[160:163], v[48:63]
    ds_read_b64_tr_b16 a[28:29], v6 offset:8192
    ds_read_b64_tr_b16 a[30:31], v6 offset:9216
    buffer_load_dwordx4 v12, s[36:39], s83 offen lds
    v_bfe_u32 v23, v1, 2, 2
    v_lshrrev_b32 v24, 5, v1
    v_lshl_add_u32 v23, v24, 3, v23
    v_lshlrev_b32 v23, 7, v23
    v_bfe_u32 v24, v1, 4, 1
    v_lshl_add_u32 v23, v24, 5, v23
    v_and_b32 v24, 3, v1
    v_lshl_add_u32 v23, v24, 3, v23
    v_bfe_u32 v24, v1, 3, 1
    v_lshl_add_u32 v23, v24, 6, v23
    v_add_u32 v3, s90, v23
    v_xor_b32 v4, 64, v3
    v_mfma_f32_32x32x16_bf16 v[64:79], a[8:11], v[160:163], v[64:79]
    ds_read_b64_tr_b16 a[32:33], v7 offset:8192
    ds_read_b64_tr_b16 a[34:35], v7 offset:9216
    buffer_load_dwordx4 v0, s[36:39], s83 offen offset:1024 lds
    s_waitcnt lgkmcnt(6)
    v_mfma_f32_32x32x16_bf16 v[80:95], a[12:15], v[160:163], v[80:95]
    ds_read_b64_tr_b16 a[36:37], v8 offset:8192
    ds_read_b64_tr_b16 a[38:39], v8 offset:9216
    s_add_u32 m0, s90, 4096
    v_mfma_f32_32x32x16_bf16 v[96:111], a[16:19], v[160:163], v[96:111]
    ds_read_b64_tr_b16 a[40:41], v9 offset:8192
    ds_read_b64_tr_b16 a[42:43], v9 offset:9216
    buffer_load_dwordx4 v13, s[24:27], s42 offen lds
    v_mfma_f32_32x32x16_bf16 v[112:127], a[20:23], v[160:163], v[112:127]
    ds_read_b64_tr_b16 a[44:45], v10 offset:8192
    ds_read_b64_tr_b16 a[46:47], v10 offset:9216
    buffer_load_dwordx4 v14, s[24:27], s42 offen offset:1024 lds
    s_add_u32 s42, s42, 65536
    s_cmp_eq_u32 s42, s44
    s_cselect_b32 s42, s89, s42
    s_waitcnt lgkmcnt(6)
    v_mfma_f32_32x32x16_bf16 v[32:47], a[24:27], v[164:167], v[32:47]
    ds_read_b64_tr_b16 a[0:1], v5 offset:16384
    ds_read_b64_tr_b16 a[2:3], v5 offset:17408
    s_add_u32 s83, s59, 132096
    s_add_u32 m0, s82, 57344
    s_and_b32 s77, s87, 3
    v_mfma_f32_32x32x16_bf16 v[48:63], a[28:31], v[164:167], v[48:63]
    ds_read_b64_tr_b16 a[4:5], v6 offset:16384
    ds_read_b64_tr_b16 a[6:7], v6 offset:17408
    buffer_load_dwordx4 v12, s[36:39], s83 offen lds
    v_mfma_f32_32x32x16_bf16 v[64:79], a[32:35], v[164:167], v[64:79]
    ds_read_b64_tr_b16 a[8:9], v7 offset:16384
    ds_read_b64_tr_b16 a[10:11], v7 offset:17408
    buffer_load_dwordx4 v0, s[36:39], s83 offen offset:1024 lds
    s_waitcnt lgkmcnt(6)
    v_mfma_f32_32x32x16_bf16 v[80:95], a[36:39], v[164:167], v[80:95]
    ds_read_b64_tr_b16 a[12:13], v8 offset:16384
    ds_read_b64_tr_b16 a[14:15], v8 offset:17408
    s_lshl_b32 s77, s77, 1
    v_mfma_f32_32x32x16_bf16 v[96:111], a[40:43], v[164:167], v[96:111]
    ds_read_b64_tr_b16 a[16:17], v9 offset:16384
    ds_read_b64_tr_b16 a[18:19], v9 offset:17408
    v_mfma_f32_32x32x16_bf16 v[112:127], a[44:47], v[164:167], v[112:127]
    ds_read_b64_tr_b16 a[20:21], v10 offset:16384
    ds_read_b64_tr_b16 a[22:23], v10 offset:17408
    s_waitcnt vmcnt(10)
    s_barrier
    s_waitcnt lgkmcnt(6)
    v_mfma_f32_32x32x16_bf16 v[32:47], a[0:3], v[168:171], v[32:47]
    ds_read_b64_tr_b16 a[24:25], v5 offset:24576
    ds_read_b64_tr_b16 a[26:27], v5 offset:25600
    s_add_u32 m0, s82, 0
    s_add_u32 s76, s77, s88
    v_mfma_f32_32x32x16_bf16 v[48:63], a[4:7], v[168:171], v[48:63]
    ds_read_b64_tr_b16 a[28:29], v6 offset:24576
    ds_read_b64_tr_b16 a[30:31], v6 offset:25600
    buffer_load_dwordx4 v12, s[36:39], s60 offen lds
    v_mfma_f32_32x32x16_bf16 v[64:79], a[8:11], v[168:171], v[64:79]
    ds_read_b64_tr_b16 a[32:33], v7 offset:24576
    ds_read_b64_tr_b16 a[34:35], v7 offset:25600
    buffer_load_dwordx4 v0, s[36:39], s60 offen offset:1024 lds
    s_waitcnt lgkmcnt(6)
    v_mfma_f32_32x32x16_bf16 v[80:95], a[12:15], v[168:171], v[80:95]
    ds_read_b64_tr_b16 a[36:37], v8 offset:24576
    ds_read_b64_tr_b16 a[38:39], v8 offset:25600
    s_add_u32 m0, s90, 6144
    s_mul_i32 s76, s76, 3
    v_mfma_f32_32x32x16_bf16 v[96:111], a[16:19], v[168:171], v[96:111]
    ds_read_b64_tr_b16 a[40:41], v9 offset:24576
    ds_read_b64_tr_b16 a[42:43], v9 offset:25600
    buffer_load_dwordx4 v13, s[24:27], s42 offen lds
    v_mfma_f32_32x32x16_bf16 v[112:127], a[20:23], v[168:171], v[112:127]
    ds_read_b64_tr_b16 a[44:45], v10 offset:24576
    ds_read_b64_tr_b16 a[46:47], v10 offset:25600
    buffer_load_dwordx4 v14, s[24:27], s42 offen offset:1024 lds
    s_add_u32 s42, s42, 65536
    s_cmp_eq_u32 s42, s44
    s_cselect_b32 s42, s89, s42
    s_waitcnt lgkmcnt(6)
    v_mfma_f32_32x32x16_bf16 v[32:47], a[24:27], v[172:175], v[32:47]
    ds_read_b64_tr_b16 a[0:1], v5 offset:32768
    ds_read_b64_tr_b16 a[2:3], v5 offset:33792
    s_add_u32 s83, s60, 44032
    s_add_u32 m0, s82, 8192
    s_sub_u32 s78, s76, 22
    v_mfma_f32_32x32x16_bf16 v[48:63], a[28:31], v[172:175], v[48:63]
    ds_read_b64_tr_b16 a[4:5], v6 offset:32768
    ds_read_b64_tr_b16 a[6:7], v6 offset:33792
    buffer_load_dwordx4 v12, s[36:39], s83 offen lds
    s_and_b32 s74, s87, 3
    s_lshl_b32 s74, s74, 17
    s_add_u32 s74, s74, s89
    buffer_load_dwordx4 v[128:131], v13, s[20:23], s74 offen
    v_mfma_f32_32x32x16_bf16 v[64:79], a[32:35], v[172:175], v[64:79]
    ds_read_b64_tr_b16 a[8:9], v7 offset:32768
    ds_read_b64_tr_b16 a[10:11], v7 offset:33792
    buffer_load_dwordx4 v0, s[36:39], s83 offen offset:1024 lds
    s_waitcnt lgkmcnt(6)
    v_mfma_f32_32x32x16_bf16 v[80:95], a[36:39], v[172:175], v[80:95]
    ds_read_b64_tr_b16 a[12:13], v8 offset:32768
    ds_read_b64_tr_b16 a[14:15], v8 offset:33792
    s_cmp_ge_u32 s76, 22
    s_cselect_b32 s76, s78, s76
    v_mfma_f32_32x32x16_bf16 v[96:111], a[40:43], v[172:175], v[96:111]
    ds_read_b64_tr_b16 a[16:17], v9 offset:32768
    ds_read_b64_tr_b16 a[18:19], v9 offset:33792
    v_mfma_f32_32x32x16_bf16 v[112:127], a[44:47], v[172:175], v[112:127]
    ds_read_b64_tr_b16 a[20:21], v10 offset:32768
    ds_read_b64_tr_b16 a[22:23], v10 offset:33792
    s_waitcnt vmcnt(11)
    s_barrier
    s_waitcnt lgkmcnt(6)
    v_mfma_f32_32x32x16_bf16 v[32:47], a[0:3], v[176:179], v[32:47]
    ds_read_b64_tr_b16 a[24:25], v5 offset:40960
    ds_read_b64_tr_b16 a[26:27], v5 offset:41984
    s_add_u32 s83, s60, 88064
    s_add_u32 m0, s82, 16384
    s_add_u32 s77, s77, s88
    v_mfma_f32_32x32x16_bf16 v[48:63], a[4:7], v[176:179], v[48:63]
    ds_read_b64_tr_b16 a[28:29], v6 offset:40960
    ds_read_b64_tr_b16 a[30:31], v6 offset:41984
    buffer_load_dwordx4 v12, s[36:39], s83 offen lds
    v_mfma_f32_32x32x16_bf16 v[64:79], a[8:11], v[176:179], v[64:79]
    ds_read_b64_tr_b16 a[32:33], v7 offset:40960
    ds_read_b64_tr_b16 a[34:35], v7 offset:41984
    buffer_load_dwordx4 v0, s[36:39], s83 offen offset:1024 lds
    s_waitcnt lgkmcnt(6)
    v_mfma_f32_32x32x16_bf16 v[80:95], a[12:15], v[176:179], v[80:95]
    ds_read_b64_tr_b16 a[36:37], v8 offset:40960
    ds_read_b64_tr_b16 a[38:39], v8 offset:41984
    s_add_u32 m0, s90, 8192
    s_and_b32 s77, s77, 7
    v_mfma_f32_32x32x16_bf16 v[96:111], a[16:19], v[176:179], v[96:111]
    ds_read_b64_tr_b16 a[40:41], v9 offset:40960
    ds_read_b64_tr_b16 a[42:43], v9 offset:41984
    buffer_load_dwordx4 v13, s[24:27], s42 offen lds
    v_mfma_f32_32x32x16_bf16 v[112:127], a[20:23], v[176:179], v[112:127]
    ds_read_b64_tr_b16 a[44:45], v10 offset:40960
    ds_read_b64_tr_b16 a[46:47], v10 offset:41984
    buffer_load_dwordx4 v14, s[24:27], s42 offen offset:1024 lds
    s_add_u32 s42, s42, 65536
    s_cmp_eq_u32 s42, s44
    s_cselect_b32 s42, s89, s42
    s_waitcnt lgkmcnt(6)
    v_mfma_f32_32x32x16_bf16 v[32:47], a[24:27], v[180:183], v[32:47]
    ds_read_b64_tr_b16 a[0:1], v5 offset:49152
    ds_read_b64_tr_b16 a[2:3], v5 offset:50176
    s_add_u32 s83, s60, 132096
    s_add_u32 m0, s82, 24576
    s_lshl_b32 s92, s87, 1
    v_mfma_f32_32x32x16_bf16 v[48:63], a[28:31], v[180:183], v[48:63]
    ds_read_b64_tr_b16 a[4:5], v6 offset:49152
    ds_read_b64_tr_b16 a[6:7], v6 offset:50176
    buffer_load_dwordx4 v12, s[36:39], s83 offen lds
    s_add_u32 s74, s74, 8192
    buffer_load_dwordx4 v[132:135], v13, s[20:23], s74 offen
    v_mfma_f32_32x32x16_bf16 v[64:79], a[32:35], v[180:183], v[64:79]
    ds_read_b64_tr_b16 a[8:9], v7 offset:49152
    ds_read_b64_tr_b16 a[10:11], v7 offset:50176
    buffer_load_dwordx4 v0, s[36:39], s83 offen offset:1024 lds
    s_waitcnt lgkmcnt(6)
    v_mfma_f32_32x32x16_bf16 v[80:95], a[36:39], v[180:183], v[80:95]
    ds_read_b64_tr_b16 a[12:13], v8 offset:49152
    ds_read_b64_tr_b16 a[14:15], v8 offset:50176
    s_mul_i32 s92, s92, 118
    v_mfma_f32_32x32x16_bf16 v[96:111], a[40:43], v[180:183], v[96:111]
    ds_read_b64_tr_b16 a[16:17], v9 offset:49152
    ds_read_b64_tr_b16 a[18:19], v9 offset:50176
    v_mfma_f32_32x32x16_bf16 v[112:127], a[44:47], v[180:183], v[112:127]
    ds_read_b64_tr_b16 a[20:21], v10 offset:49152
    ds_read_b64_tr_b16 a[22:23], v10 offset:50176
    s_waitcnt vmcnt(12)
    s_barrier
    s_waitcnt lgkmcnt(6)
    v_mfma_f32_32x32x16_bf16 v[32:47], a[0:3], v[184:187], v[32:47]
    ds_read_b64_tr_b16 a[24:25], v5 offset:57344
    ds_read_b64_tr_b16 a[26:27], v5 offset:58368
    s_add_u32 m0, s82, 32768
    s_add_u32 s92, s92, s68
    v_mfma_f32_32x32x16_bf16 v[48:63], a[4:7], v[184:187], v[48:63]
    ds_read_b64_tr_b16 a[28:29], v6 offset:57344
    ds_read_b64_tr_b16 a[30:31], v6 offset:58368
    buffer_load_dwordx4 v12, s[36:39], s61 offen lds
    v_mfma_f32_32x32x16_bf16 v[64:79], a[8:11], v[184:187], v[64:79]
    ds_read_b64_tr_b16 a[32:33], v7 offset:57344
    ds_read_b64_tr_b16 a[34:35], v7 offset:58368
    buffer_load_dwordx4 v0, s[36:39], s61 offen offset:1024 lds
    s_waitcnt lgkmcnt(6)
    v_mfma_f32_32x32x16_bf16 v[80:95], a[12:15], v[184:187], v[80:95]
    ds_read_b64_tr_b16 a[36:37], v8 offset:57344
    ds_read_b64_tr_b16 a[38:39], v8 offset:58368
    s_add_u32 m0, s90, 10240
    s_lshl_b32 s92, s92, 10
    v_mfma_f32_32x32x16_bf16 v[96:111], a[16:19], v[184:187], v[96:111]
    ds_read_b64_tr_b16 a[40:41], v9 offset:57344
    ds_read_b64_tr_b16 a[42:43], v9 offset:58368
    buffer_load_dwordx4 v13, s[24:27], s42 offen lds
    v_mfma_f32_32x32x16_bf16 v[112:127], a[20:23], v[184:187], v[112:127]
    ds_read_b64_tr_b16 a[44:45], v10 offset:57344
    ds_read_b64_tr_b16 a[46:47], v10 offset:58368
    buffer_load_dwordx4 v14, s[24:27], s42 offen offset:1024 lds
    s_add_u32 s42, s42, 65536
    s_cmp_eq_u32 s42, s44
    s_cselect_b32 s42, s89, s42
    s_waitcnt lgkmcnt(6)
    v_mfma_f32_32x32x16_bf16 v[32:47], a[24:27], v[188:191], v[32:47]
    ds_read_b64_tr_b16 a[0:1], v5 offset:0
    ds_read_b64_tr_b16 a[2:3], v5 offset:1024
    s_add_u32 s83, s61, 44032
    s_add_u32 m0, s82, 40960
    s_add_u32 s92, s92, 2097152
    v_mfma_f32_32x32x16_bf16 v[48:63], a[28:31], v[188:191], v[48:63]
    ds_read_b64_tr_b16 a[4:5], v6 offset:0
    ds_read_b64_tr_b16 a[6:7], v6 offset:1024
    buffer_load_dwordx4 v12, s[36:39], s83 offen lds
    s_add_u32 s74, s74, 57344
    buffer_load_dwordx4 v[136:139], v13, s[20:23], s74 offen
    v_mfma_f32_32x32x16_bf16 v[64:79], a[32:35], v[188:191], v[64:79]
    ds_read_b64_tr_b16 a[8:9], v7 offset:0
    ds_read_b64_tr_b16 a[10:11], v7 offset:1024
    buffer_load_dwordx4 v0, s[36:39], s83 offen offset:1024 lds
    s_waitcnt lgkmcnt(6)
    v_mfma_f32_32x32x16_bf16 v[80:95], a[36:39], v[188:191], v[80:95]
    ds_read_b64_tr_b16 a[12:13], v8 offset:0
    ds_read_b64_tr_b16 a[14:15], v8 offset:1024
    s_lshl_b32 s46, s76, 12
    v_mfma_f32_32x32x16_bf16 v[96:111], a[40:43], v[188:191], v[96:111]
    ds_read_b64_tr_b16 a[16:17], v9 offset:0
    ds_read_b64_tr_b16 a[18:19], v9 offset:1024
    v_mfma_f32_32x32x16_bf16 v[112:127], a[44:47], v[188:191], v[112:127]
    ds_read_b64_tr_b16 a[20:21], v10 offset:0
    ds_read_b64_tr_b16 a[22:23], v10 offset:1024
    s_waitcnt vmcnt(12)
    s_barrier
    s_waitcnt lgkmcnt(6)
    v_mfma_f32_32x32x16_bf16 v[32:47], a[0:3], v[192:195], v[32:47]
    ds_read_b64_tr_b16 a[24:25], v5 offset:8192
    ds_read_b64_tr_b16 a[26:27], v5 offset:9216
    s_add_u32 s83, s61, 88064
    s_add_u32 m0, s82, 49152
    s_add_u32 s46, s46, s92
    v_mfma_f32_32x32x16_bf16 v[48:63], a[4:7], v[192:195], v[48:63]
    ds_read_b64_tr_b16 a[28:29], v6 offset:8192
    ds_read_b64_tr_b16 a[30:31], v6 offset:9216
    buffer_load_dwordx4 v12, s[36:39], s83 offen lds
    v_mfma_f32_32x32x16_bf16 v[64:79], a[8:11], v[192:195], v[64:79]
    ds_read_b64_tr_b16 a[32:33], v7 offset:8192
    ds_read_b64_tr_b16 a[34:35], v7 offset:9216
    buffer_load_dwordx4 v0, s[36:39], s83 offen offset:1024 lds
    s_waitcnt lgkmcnt(6)
    v_mfma_f32_32x32x16_bf16 v[80:95], a[12:15], v[192:195], v[80:95]
    ds_read_b64_tr_b16 a[36:37], v8 offset:8192
    ds_read_b64_tr_b16 a[38:39], v8 offset:9216
    s_add_u32 m0, s90, 12288
    s_add_u32 s93, s92, 90112
    v_mfma_f32_32x32x16_bf16 v[96:111], a[16:19], v[192:195], v[96:111]
    ds_read_b64_tr_b16 a[40:41], v9 offset:8192
    ds_read_b64_tr_b16 a[42:43], v9 offset:9216
    buffer_load_dwordx4 v13, s[24:27], s42 offen lds
    v_mfma_f32_32x32x16_bf16 v[112:127], a[20:23], v[192:195], v[112:127]
    ds_read_b64_tr_b16 a[44:45], v10 offset:8192
    ds_read_b64_tr_b16 a[46:47], v10 offset:9216
    buffer_load_dwordx4 v14, s[24:27], s42 offen offset:1024 lds
    s_add_u32 s42, s42, 65536
    s_cmp_eq_u32 s42, s44
    s_cselect_b32 s42, s89, s42
    s_waitcnt lgkmcnt(6)
    v_mfma_f32_32x32x16_bf16 v[32:47], a[24:27], v[196:199], v[32:47]
    ds_read_b64_tr_b16 a[0:1], v5 offset:16384
    ds_read_b64_tr_b16 a[2:3], v5 offset:17408
    s_add_u32 s83, s61, 132096
    s_add_u32 m0, s82, 57344
    s_lshl_b32 s47, s77, 12
    v_mfma_f32_32x32x16_bf16 v[48:63], a[28:31], v[196:199], v[48:63]
    ds_read_b64_tr_b16 a[4:5], v6 offset:16384
    ds_read_b64_tr_b16 a[6:7], v6 offset:17408
    buffer_load_dwordx4 v12, s[36:39], s83 offen lds
    s_add_u32 s74, s74, 8192
    buffer_load_dwordx4 v[140:143], v13, s[20:23], s74 offen
    v_mfma_f32_32x32x16_bf16 v[64:79], a[32:35], v[196:199], v[64:79]
    ds_read_b64_tr_b16 a[8:9], v7 offset:16384
    ds_read_b64_tr_b16 a[10:11], v7 offset:17408
    buffer_load_dwordx4 v0, s[36:39], s83 offen offset:1024 lds
    s_waitcnt lgkmcnt(6)
    v_mfma_f32_32x32x16_bf16 v[80:95], a[36:39], v[196:199], v[80:95]
    ds_read_b64_tr_b16 a[12:13], v8 offset:16384
    ds_read_b64_tr_b16 a[14:15], v8 offset:17408
    s_add_u32 s47, s47, s92
    v_mfma_f32_32x32x16_bf16 v[96:111], a[40:43], v[196:199], v[96:111]
    ds_read_b64_tr_b16 a[16:17], v9 offset:16384
    ds_read_b64_tr_b16 a[18:19], v9 offset:17408
    v_mfma_f32_32x32x16_bf16 v[112:127], a[44:47], v[196:199], v[112:127]
    ds_read_b64_tr_b16 a[20:21], v10 offset:16384
    ds_read_b64_tr_b16 a[22:23], v10 offset:17408
    s_waitcnt vmcnt(12)
    s_barrier
    s_waitcnt lgkmcnt(6)
    v_mfma_f32_32x32x16_bf16 v[32:47], a[0:3], v[200:203], v[32:47]
    ds_read_b64_tr_b16 a[24:25], v5 offset:24576
    ds_read_b64_tr_b16 a[26:27], v5 offset:25600
    s_add_u32 m0, s82, 0
    s_add_u32 s47, s47, 88064
    v_mfma_f32_32x32x16_bf16 v[48:63], a[4:7], v[200:203], v[48:63]
    ds_read_b64_tr_b16 a[28:29], v6 offset:24576
    ds_read_b64_tr_b16 a[30:31], v6 offset:25600
    buffer_load_dwordx4 v12, s[36:39], s62 offen lds
    v_mfma_f32_32x32x16_bf16 v[64:79], a[8:11], v[200:203], v[64:79]
    ds_read_b64_tr_b16 a[32:33], v7 offset:24576
    ds_read_b64_tr_b16 a[34:35], v7 offset:25600
    buffer_load_dwordx4 v0, s[36:39], s62 offen offset:1024 lds
    s_waitcnt lgkmcnt(6)
    v_mfma_f32_32x32x16_bf16 v[80:95], a[12:15], v[200:203], v[80:95]
    ds_read_b64_tr_b16 a[36:37], v8 offset:24576
    ds_read_b64_tr_b16 a[38:39], v8 offset:25600
    s_add_u32 m0, s90, 14336
    v_mfma_f32_32x32x16_bf16 v[96:111], a[16:19], v[200:203], v[96:111]
    ds_read_b64_tr_b16 a[40:41], v9 offset:24576
    ds_read_b64_tr_b16 a[42:43], v9 offset:25600
    buffer_load_dwordx4 v13, s[24:27], s42 offen lds
    v_mfma_f32_32x32x16_bf16 v[112:127], a[20:23], v[200:203], v[112:127]
    ds_read_b64_tr_b16 a[44:45], v10 offset:24576
    ds_read_b64_tr_b16 a[46:47], v10 offset:25600
    buffer_load_dwordx4 v14, s[24:27], s42 offen offset:1024 lds
    s_add_u32 s42, s42, 65536
    s_cmp_eq_u32 s42, s44
    s_cselect_b32 s42, s89, s42
    s_waitcnt lgkmcnt(6)
    v_mfma_f32_32x32x16_bf16 v[32:47], a[24:27], v[204:207], v[32:47]
    ds_read_b64_tr_b16 a[0:1], v5 offset:32768
    ds_read_b64_tr_b16 a[2:3], v5 offset:33792
    s_add_u32 s83, s62, 44032
    s_add_u32 m0, s82, 8192
    v_mfma_f32_32x32x16_bf16 v[48:63], a[28:31], v[204:207], v[48:63]
    ds_read_b64_tr_b16 a[4:5], v6 offset:32768
    ds_read_b64_tr_b16 a[6:7], v6 offset:33792
    buffer_load_dwordx4 v12, s[36:39], s83 offen lds
    v_mfma_f32_32x32x16_bf16 v[64:79], a[32:35], v[204:207], v[64:79]
    ds_read_b64_tr_b16 a[8:9], v7 offset:32768
    ds_read_b64_tr_b16 a[10:11], v7 offset:33792
    buffer_load_dwordx4 v0, s[36:39], s83 offen offset:1024 lds
    s_waitcnt lgkmcnt(6)
    v_mfma_f32_32x32x16_bf16 v[80:95], a[36:39], v[204:207], v[80:95]
    ds_read_b64_tr_b16 a[12:13], v8 offset:32768
    ds_read_b64_tr_b16 a[14:15], v8 offset:33792
    v_mfma_f32_32x32x16_bf16 v[96:111], a[40:43], v[204:207], v[96:111]
    ds_read_b64_tr_b16 a[16:17], v9 offset:32768
    ds_read_b64_tr_b16 a[18:19], v9 offset:33792
    v_mfma_f32_32x32x16_bf16 v[112:127], a[44:47], v[204:207], v[112:127]
    ds_read_b64_tr_b16 a[20:21], v10 offset:32768
    ds_read_b64_tr_b16 a[22:23], v10 offset:33792
    s_waitcnt vmcnt(11)
    s_barrier
    s_waitcnt lgkmcnt(6)
    v_mfma_f32_32x32x16_bf16 v[32:47], a[0:3], v[208:211], v[32:47]
    ds_read_b64_tr_b16 a[24:25], v5 offset:40960
    ds_read_b64_tr_b16 a[26:27], v5 offset:41984
    s_add_u32 s83, s62, 88064
    s_add_u32 m0, s82, 16384
    v_mfma_f32_32x32x16_bf16 v[48:63], a[4:7], v[208:211], v[48:63]
    ds_read_b64_tr_b16 a[28:29], v6 offset:40960
    ds_read_b64_tr_b16 a[30:31], v6 offset:41984
    buffer_load_dwordx4 v12, s[36:39], s83 offen lds
    v_mfma_f32_32x32x16_bf16 v[64:79], a[8:11], v[208:211], v[64:79]
    ds_read_b64_tr_b16 a[32:33], v7 offset:40960
    ds_read_b64_tr_b16 a[34:35], v7 offset:41984
    buffer_load_dwordx4 v0, s[36:39], s83 offen offset:1024 lds
    s_waitcnt lgkmcnt(6)
    v_mfma_f32_32x32x16_bf16 v[80:95], a[12:15], v[208:211], v[80:95]
    ds_read_b64_tr_b16 a[36:37], v8 offset:40960
    ds_read_b64_tr_b16 a[38:39], v8 offset:41984
    s_add_u32 m0, s90, 16384
    v_mfma_f32_32x32x16_bf16 v[96:111], a[16:19], v[208:211], v[96:111]
    ds_read_b64_tr_b16 a[40:41], v9 offset:40960
    ds_read_b64_tr_b16 a[42:43], v9 offset:41984
    buffer_load_dwordx4 v13, s[24:27], s42 offen lds
    v_mfma_f32_32x32x16_bf16 v[112:127], a[20:23], v[208:211], v[112:127]
    ds_read_b64_tr_b16 a[44:45], v10 offset:40960
    ds_read_b64_tr_b16 a[46:47], v10 offset:41984
    buffer_load_dwordx4 v14, s[24:27], s42 offen offset:1024 lds
    s_add_u32 s42, s42, 65536
    s_cmp_eq_u32 s42, s44
    s_cselect_b32 s42, s89, s42
    s_waitcnt lgkmcnt(6)
    v_mfma_f32_32x32x16_bf16 v[32:47], a[24:27], v[212:215], v[32:47]
    ds_read_b64_tr_b16 a[0:1], v5 offset:49152
    ds_read_b64_tr_b16 a[2:3], v5 offset:50176
    s_add_u32 s83, s62, 132096
    s_add_u32 m0, s82, 24576
    v_mfma_f32_32x32x16_bf16 v[48:63], a[28:31], v[212:215], v[48:63]
    ds_read_b64_tr_b16 a[4:5], v6 offset:49152
    ds_read_b64_tr_b16 a[6:7], v6 offset:50176
    buffer_load_dwordx4 v12, s[36:39], s83 offen lds
    v_mfma_f32_32x32x16_bf16 v[64:79], a[32:35], v[212:215], v[64:79]
    ds_read_b64_tr_b16 a[8:9], v7 offset:49152
    ds_read_b64_tr_b16 a[10:11], v7 offset:50176
    buffer_load_dwordx4 v0, s[36:39], s83 offen offset:1024 lds
    s_waitcnt lgkmcnt(6)
    v_mfma_f32_32x32x16_bf16 v[80:95], a[36:39], v[212:215], v[80:95]
    ds_read_b64_tr_b16 a[12:13], v8 offset:49152
    ds_read_b64_tr_b16 a[14:15], v8 offset:50176
    v_mfma_f32_32x32x16_bf16 v[96:111], a[40:43], v[212:215], v[96:111]
    ds_read_b64_tr_b16 a[16:17], v9 offset:49152
    ds_read_b64_tr_b16 a[18:19], v9 offset:50176
    v_mfma_f32_32x32x16_bf16 v[112:127], a[44:47], v[212:215], v[112:127]
    ds_read_b64_tr_b16 a[20:21], v10 offset:49152
    ds_read_b64_tr_b16 a[22:23], v10 offset:50176
    s_waitcnt vmcnt(10)
    s_barrier
    s_waitcnt lgkmcnt(6)
    v_mfma_f32_32x32x16_bf16 v[32:47], a[0:3], v[216:219], v[32:47]
    ds_read_b64_tr_b16 a[24:25], v5 offset:57344
    ds_read_b64_tr_b16 a[26:27], v5 offset:58368
    s_add_u32 m0, s82, 32768
    v_mfma_f32_32x32x16_bf16 v[48:63], a[4:7], v[216:219], v[48:63]
    ds_read_b64_tr_b16 a[28:29], v6 offset:57344
    ds_read_b64_tr_b16 a[30:31], v6 offset:58368
    buffer_load_dwordx4 v12, s[36:39], s63 offen lds
    v_mfma_f32_32x32x16_bf16 v[64:79], a[8:11], v[216:219], v[64:79]
    ds_read_b64_tr_b16 a[32:33], v7 offset:57344
    ds_read_b64_tr_b16 a[34:35], v7 offset:58368
    buffer_load_dwordx4 v0, s[36:39], s63 offen offset:1024 lds
    s_waitcnt lgkmcnt(6)
    v_mfma_f32_32x32x16_bf16 v[80:95], a[12:15], v[216:219], v[80:95]
    ds_read_b64_tr_b16 a[36:37], v8 offset:57344
    ds_read_b64_tr_b16 a[38:39], v8 offset:58368
    s_add_u32 m0, s90, 18432
    v_mfma_f32_32x32x16_bf16 v[96:111], a[16:19], v[216:219], v[96:111]
    ds_read_b64_tr_b16 a[40:41], v9 offset:57344
    ds_read_b64_tr_b16 a[42:43], v9 offset:58368
    buffer_load_dwordx4 v13, s[24:27], s42 offen lds
    v_mfma_f32_32x32x16_bf16 v[112:127], a[20:23], v[216:219], v[112:127]
    ds_read_b64_tr_b16 a[44:45], v10 offset:57344
    ds_read_b64_tr_b16 a[46:47], v10 offset:58368
    buffer_load_dwordx4 v14, s[24:27], s42 offen offset:1024 lds
    s_add_u32 s42, s42, 65536
    s_cmp_eq_u32 s42, s44
    s_cselect_b32 s42, s89, s42
    s_waitcnt lgkmcnt(6)
    v_mfma_f32_32x32x16_bf16 v[32:47], a[24:27], v[220:223], v[32:47]
    ds_read_b64_tr_b16 a[0:1], v5 offset:0
    ds_read_b64_tr_b16 a[2:3], v5 offset:1024
    s_add_u32 s83, s63, 44032
    s_add_u32 m0, s82, 40960
    s_lshl_b32 s41, s70, 7
    s_add_u32 s41, s41, 4096
    v_and_b32 v28, 15, v1
    v_lshlrev_b32 v28, 2, v28
    buffer_load_dword v29, v28, s[32:35], s41 offen sc1
    v_mfma_f32_32x32x16_bf16 v[48:63], a[28:31], v[220:223], v[48:63]
    ds_read_b64_tr_b16 a[4:5], v6 offset:0
    ds_read_b64_tr_b16 a[6:7], v6 offset:1024
    buffer_load_dwordx4 v12, s[36:39], s83 offen lds
    v_mfma_f32_32x32x16_bf16 v[64:79], a[32:35], v[220:223], v[64:79]
    ds_read_b64_tr_b16 a[8:9], v7 offset:0
    ds_read_b64_tr_b16 a[10:11], v7 offset:1024
    buffer_load_dwordx4 v0, s[36:39], s83 offen offset:1024 lds
    s_waitcnt lgkmcnt(6)
    v_mfma_f32_32x32x16_bf16 v[80:95], a[36:39], v[220:223], v[80:95]
    ds_read_b64_tr_b16 a[12:13], v8 offset:0
    ds_read_b64_tr_b16 a[14:15], v8 offset:1024
    v_mfma_f32_32x32x16_bf16 v[96:111], a[40:43], v[220:223], v[96:111]
    ds_read_b64_tr_b16 a[16:17], v9 offset:0
    ds_read_b64_tr_b16 a[18:19], v9 offset:1024
    v_mfma_f32_32x32x16_bf16 v[112:127], a[44:47], v[220:223], v[112:127]
    ds_read_b64_tr_b16 a[20:21], v10 offset:0
    ds_read_b64_tr_b16 a[22:23], v10 offset:1024
    s_waitcnt vmcnt(11)
    s_barrier
    s_waitcnt lgkmcnt(6)
    v_mfma_f32_32x32x16_bf16 v[32:47], a[0:3], v[224:227], v[32:47]
    ds_read_b64_tr_b16 a[24:25], v5 offset:8192
    ds_read_b64_tr_b16 a[26:27], v5 offset:9216
    s_add_u32 s83, s63, 88064
    s_add_u32 m0, s82, 49152
    v_mfma_f32_32x32x16_bf16 v[48:63], a[4:7], v[224:227], v[48:63]
    ds_read_b64_tr_b16 a[28:29], v6 offset:8192
    ds_read_b64_tr_b16 a[30:31], v6 offset:9216
    buffer_load_dwordx4 v12, s[36:39], s83 offen lds
    s_waitcnt vmcnt(62)
    ds_read_b64_tr_b16 a[104:105], v3 offset:0
    ds_read_b64_tr_b16 a[106:107], v3 offset:512
    ds_read_b64_tr_b16 a[108:109], v4 offset:0
    ds_read_b64_tr_b16 a[110:111], v4 offset:512
    v_mfma_f32_32x32x16_bf16 v[64:79], a[8:11], v[224:227], v[64:79]
    ds_read_b64_tr_b16 a[32:33], v7 offset:8192
    ds_read_b64_tr_b16 a[34:35], v7 offset:9216
    buffer_load_dwordx4 v0, s[36:39], s83 offen offset:1024 lds
    s_waitcnt vmcnt(57)
    ds_read_b64_tr_b16 a[112:113], v3 offset:2048
    ds_read_b64_tr_b16 a[114:115], v3 offset:2560
    ds_read_b64_tr_b16 a[116:117], v4 offset:2048
    ds_read_b64_tr_b16 a[118:119], v4 offset:2560
    s_waitcnt lgkmcnt(14)
    v_mfma_f32_32x32x16_bf16 v[80:95], a[12:15], v[224:227], v[80:95]
    ds_read_b64_tr_b16 a[36:37], v8 offset:8192
    ds_read_b64_tr_b16 a[38:39], v8 offset:9216
    s_add_u32 m0, s90, 20480
    v_mfma_f32_32x32x16_bf16 v[96:111], a[16:19], v[224:227], v[96:111]
    ds_read_b64_tr_b16 a[40:41], v9 offset:8192
    ds_read_b64_tr_b16 a[42:43], v9 offset:9216
    buffer_load_dwordx4 v13, s[24:27], s42 offen lds
    v_mfma_f32_32x32x16_bf16 v[112:127], a[20:23], v[224:227], v[112:127]
    ds_read_b64_tr_b16 a[44:45], v10 offset:8192
    ds_read_b64_tr_b16 a[46:47], v10 offset:9216
    buffer_load_dwordx4 v14, s[24:27], s42 offen offset:1024 lds
    s_add_u32 s42, s42, 65536
    s_cmp_eq_u32 s42, s44
    s_cselect_b32 s42, s89, s42
    s_waitcnt lgkmcnt(10)
    v_mfma_f32_32x32x16_bf16 v[32:47], a[24:27], v[228:231], v[32:47]
    ds_read_b64_tr_b16 a[0:1], v5 offset:16384
    ds_read_b64_tr_b16 a[2:3], v5 offset:17408
    s_add_u32 s83, s63, 132096
    s_add_u32 m0, s82, 57344
    v_mfma_f32_32x32x16_bf16 v[48:63], a[28:31], v[228:231], v[48:63]
    ds_read_b64_tr_b16 a[4:5], v6 offset:16384
    ds_read_b64_tr_b16 a[6:7], v6 offset:17408
    buffer_load_dwordx4 v12, s[36:39], s83 offen lds
    s_waitcnt vmcnt(54)
    ds_read_b64_tr_b16 a[120:121], v3 offset:4096
    ds_read_b64_tr_b16 a[122:123], v3 offset:4608
    ds_read_b64_tr_b16 a[124:125], v4 offset:4096
    ds_read_b64_tr_b16 a[126:127], v4 offset:4608
    v_mfma_f32_32x32x16_bf16 v[64:79], a[32:35], v[228:231], v[64:79]
    ds_read_b64_tr_b16 a[8:9], v7 offset:16384
    ds_read_b64_tr_b16 a[10:11], v7 offset:17408
    buffer_load_dwordx4 v0, s[36:39], s83 offen offset:1024 lds
    s_waitcnt vmcnt(49)
    ds_read_b64_tr_b16 a[128:129], v3 offset:6144
    ds_read_b64_tr_b16 a[130:131], v3 offset:6656
    ds_read_b64_tr_b16 a[132:133], v4 offset:6144
    ds_read_b64_tr_b16 a[134:135], v4 offset:6656
    s_waitcnt lgkmcnt(14)
    v_mfma_f32_32x32x16_bf16 v[80:95], a[36:39], v[228:231], v[80:95]
    ds_read_b64_tr_b16 a[12:13], v8 offset:16384
    ds_read_b64_tr_b16 a[14:15], v8 offset:17408
    v_mfma_f32_32x32x16_bf16 v[96:111], a[40:43], v[228:231], v[96:111]
    ds_read_b64_tr_b16 a[16:17], v9 offset:16384
    ds_read_b64_tr_b16 a[18:19], v9 offset:17408
    v_mfma_f32_32x32x16_bf16 v[112:127], a[44:47], v[228:231], v[112:127]
    ds_read_b64_tr_b16 a[20:21], v10 offset:16384
    ds_read_b64_tr_b16 a[22:23], v10 offset:17408
    s_waitcnt vmcnt(11)
    s_barrier
    s_waitcnt lgkmcnt(10)
    v_mfma_f32_32x32x16_bf16 v[32:47], a[0:3], v[232:235], v[32:47]
    ds_read_b64_tr_b16 a[24:25], v5 offset:24576
    ds_read_b64_tr_b16 a[26:27], v5 offset:25600
    v_mfma_f32_32x32x16_bf16 v[48:63], a[4:7], v[232:235], v[48:63]
    ds_read_b64_tr_b16 a[28:29], v6 offset:24576
    ds_read_b64_tr_b16 a[30:31], v6 offset:25600
    s_waitcnt vmcnt(42)
    ds_read_b64_tr_b16 a[136:137], v3 offset:8192
    ds_read_b64_tr_b16 a[138:139], v3 offset:8704
    ds_read_b64_tr_b16 a[140:141], v4 offset:8192
    ds_read_b64_tr_b16 a[142:143], v4 offset:8704
    v_mfma_f32_32x32x16_bf16 v[64:79], a[8:11], v[232:235], v[64:79]
    ds_read_b64_tr_b16 a[32:33], v7 offset:24576
    ds_read_b64_tr_b16 a[34:35], v7 offset:25600
    s_waitcnt lgkmcnt(10)
    v_mfma_f32_32x32x16_bf16 v[80:95], a[12:15], v[232:235], v[80:95]
    ds_read_b64_tr_b16 a[36:37], v8 offset:24576
    ds_read_b64_tr_b16 a[38:39], v8 offset:25600
    s_add_u32 m0, s91, 98304
    v_mfma_f32_32x32x16_bf16 v[96:111], a[16:19], v[232:235], v[96:111]
    ds_read_b64_tr_b16 a[40:41], v9 offset:24576
    ds_read_b64_tr_b16 a[42:43], v9 offset:25600
    buffer_load_dwordx4 v13, s[24:27], s42 offen lds
    v_mfma_f32_32x32x16_bf16 v[112:127], a[20:23], v[232:235], v[112:127]
    ds_read_b64_tr_b16 a[44:45], v10 offset:24576
    ds_read_b64_tr_b16 a[46:47], v10 offset:25600
    buffer_load_dwordx4 v14, s[24:27], s42 offen offset:1024 lds
    s_add_u32 s42, s42, 65536
    s_cmp_eq_u32 s42, s44
    s_cselect_b32 s42, s89, s42
    s_waitcnt lgkmcnt(6)
    v_mfma_f32_32x32x16_bf16 v[32:47], a[24:27], v[236:239], v[32:47]
    ds_read_b64_tr_b16 a[0:1], v5 offset:32768
    ds_read_b64_tr_b16 a[2:3], v5 offset:33792
    s_waitcnt vmcnt(10)
    s_mov_b32 s94, 0
L_pkv_loop:
    v_cmp_ne_u32 vcc, s71, v29
    s_nop 4
    s_cmp_eq_u64 vcc, 0
    s_cbranch_scc1 L_pkv_done
    buffer_load_dword v29, v28, s[32:35], s41 offen sc1
    s_add_u32 s94, s94, 1
    s_waitcnt vmcnt(0)
    s_cmp_lt_u32 s94, 200000
    s_cbranch_scc1 L_pkv_loop
L_pkv_done:
    s_add_u32 s76, s95, 0
    buffer_load_dwordx4 v[128:131], v2, s[32:35], s76 offen offset:0 sc1
    v_mfma_f32_32x32x16_bf16 v[48:63], a[28:31], v[236:239], v[48:63]
    ds_read_b64_tr_b16 a[4:5], v6 offset:32768
    ds_read_b64_tr_b16 a[6:7], v6 offset:33792
    s_waitcnt vmcnt(38)
    ds_read_b64_tr_b16 a[144:145], v3 offset:10240
    ds_read_b64_tr_b16 a[146:147], v3 offset:10752
    ds_read_b64_tr_b16 a[148:149], v4 offset:10240
    ds_read_b64_tr_b16 a[150:151], v4 offset:10752
    buffer_load_dwordx4 v[132:135], v2, s[32:35], s76 offen offset:1024 sc1
    buffer_load_dwordx4 v[136:139], v2, s[32:35], s76 offen offset:2048 sc1
    v_mfma_f32_32x32x16_bf16 v[64:79], a[32:35], v[236:239], v[64:79]
    ds_read_b64_tr_b16 a[8:9], v7 offset:32768
    ds_read_b64_tr_b16 a[10:11], v7 offset:33792
    buffer_load_dwordx4 v[140:143], v2, s[32:35], s76 offen offset:3072 sc1
    s_add_u32 s76, s95, 4096
    s_waitcnt lgkmcnt(10)
    v_mfma_f32_32x32x16_bf16 v[80:95], a[36:39], v[236:239], v[80:95]
    ds_read_b64_tr_b16 a[12:13], v8 offset:32768
    ds_read_b64_tr_b16 a[14:15], v8 offset:33792
    s_add_u32 m0, s91, 106496
    v_mfma_f32_32x32x16_bf16 v[96:111], a[40:43], v[236:239], v[96:111]
    ds_read_b64_tr_b16 a[16:17], v9 offset:32768
    ds_read_b64_tr_b16 a[18:19], v9 offset:33792
    buffer_load_dwordx4 v13, s[24:27], s42 offen lds
    v_mfma_f32_32x32x16_bf16 v[112:127], a[44:47], v[236:239], v[112:127]
    ds_read_b64_tr_b16 a[20:21], v10 offset:32768
    ds_read_b64_tr_b16 a[22:23], v10 offset:33792
    buffer_load_dwordx4 v14, s[24:27], s42 offen offset:1024 lds
    s_add_u32 s42, s42, 65536
    s_cmp_eq_u32 s42, s44
    s_cselect_b32 s42, s89, s42
    s_waitcnt vmcnt(12)
    s_barrier
    s_waitcnt lgkmcnt(6)
    v_mfma_f32_32x32x16_bf16 v[32:47], a[0:3], v[240:243], v[32:47]
    ds_read_b64_tr_b16 a[24:25], v5 offset:40960
    ds_read_b64_tr_b16 a[26:27], v5 offset:41984
    buffer_load_dwordx4 v[144:147], v2, s[32:35], s76 offen offset:0 sc1
    buffer_load_dwordx4 v[148:151], v2, s[32:35], s76 offen offset:1024 sc1
    v_mfma_f32_32x32x16_bf16 v[48:63], a[4:7], v[240:243], v[48:63]
    ds_read_b64_tr_b16 a[28:29], v6 offset:40960
    ds_read_b64_tr_b16 a[30:31], v6 offset:41984
    s_waitcnt vmcnt(38)
    ds_read_b64_tr_b16 a[152:153], v3 offset:12288
    ds_read_b64_tr_b16 a[154:155], v3 offset:12800
    ds_read_b64_tr_b16 a[156:157], v4 offset:12288
    ds_read_b64_tr_b16 a[158:159], v4 offset:12800
    buffer_load_dwordx4 v[152:155], v2, s[32:35], s76 offen offset:2048 sc1
    buffer_load_dwordx4 v[156:159], v2, s[32:35], s76 offen offset:3072 sc1
    v_mfma_f32_32x32x16_bf16 v[64:79], a[8:11], v[240:243], v[64:79]
    ds_read_b64_tr_b16 a[32:33], v7 offset:40960
    ds_read_b64_tr_b16 a[34:35], v7 offset:41984
    s_add_u32 s76, s95, 8192
    buffer_load_dwordx4 v[160:163], v2, s[32:35], s76 offen offset:0 sc1
    s_waitcnt lgkmcnt(10)
    v_mfma_f32_32x32x16_bf16 v[80:95], a[12:15], v[240:243], v[80:95]
    ds_read_b64_tr_b16 a[36:37], v8 offset:40960
    ds_read_b64_tr_b16 a[38:39], v8 offset:41984
    s_add_u32 m0, s91, 114688
    v_mfma_f32_32x32x16_bf16 v[96:111], a[16:19], v[240:243], v[96:111]
    ds_read_b64_tr_b16 a[40:41], v9 offset:40960
    ds_read_b64_tr_b16 a[42:43], v9 offset:41984
    buffer_load_dwordx4 v13, s[24:27], s42 offen lds
    v_mfma_f32_32x32x16_bf16 v[112:127], a[20:23], v[240:243], v[112:127]
    ds_read_b64_tr_b16 a[44:45], v10 offset:40960
    ds_read_b64_tr_b16 a[46:47], v10 offset:41984
    buffer_load_dwordx4 v14, s[24:27], s42 offen offset:1024 lds
    s_add_u32 s42, s42, 65536
    s_cmp_eq_u32 s42, s44
    s_cselect_b32 s42, s89, s42
    s_waitcnt lgkmcnt(6)
    v_mfma_f32_32x32x16_bf16 v[32:47], a[24:27], v[244:247], v[32:47]
    ds_read_b64_tr_b16 a[0:1], v5 offset:49152
    ds_read_b64_tr_b16 a[2:3], v5 offset:50176
    buffer_load_dwordx4 v[164:167], v2, s[32:35], s76 offen offset:1024 sc1
    buffer_load_dwordx4 v[168:171], v2, s[32:35], s76 offen offset:2048 sc1
    v_mfma_f32_32x32x16_bf16 v[48:63], a[28:31], v[244:247], v[48:63]
    ds_read_b64_tr_b16 a[4:5], v6 offset:49152
    ds_read_b64_tr_b16 a[6:7], v6 offset:50176
    s_waitcnt vmcnt(38)
    ds_read_b64_tr_b16 a[160:161], v3 offset:14336
    ds_read_b64_tr_b16 a[162:163], v3 offset:14848
    ds_read_b64_tr_b16 a[164:165], v4 offset:14336
    ds_read_b64_tr_b16 a[166:167], v4 offset:14848
    buffer_load_dwordx4 v[172:175], v2, s[32:35], s76 offen offset:3072 sc1
    s_add_u32 s76, s95, 12288
    v_mfma_f32_32x32x16_bf16 v[64:79], a[32:35], v[244:247], v[64:79]
    ds_read_b64_tr_b16 a[8:9], v7 offset:49152
    ds_read_b64_tr_b16 a[10:11], v7 offset:50176
    buffer_load_dwordx4 v[176:179], v2, s[32:35], s76 offen offset:0 sc1
    buffer_load_dwordx4 v[180:183], v2, s[32:35], s76 offen offset:1024 sc1
    s_waitcnt lgkmcnt(10)
    v_mfma_f32_32x32x16_bf16 v[80:95], a[36:39], v[244:247], v[80:95]
    ds_read_b64_tr_b16 a[12:13], v8 offset:49152
    ds_read_b64_tr_b16 a[14:15], v8 offset:50176
    s_add_u32 m0, s91, 122880
    v_mfma_f32_32x32x16_bf16 v[96:111], a[40:43], v[244:247], v[96:111]
    ds_read_b64_tr_b16 a[16:17], v9 offset:49152
    ds_read_b64_tr_b16 a[18:19], v9 offset:50176
    buffer_load_dwordx4 v13, s[24:27], s42 offen lds
    v_mfma_f32_32x32x16_bf16 v[112:127], a[44:47], v[244:247], v[112:127]
    ds_read_b64_tr_b16 a[20:21], v10 offset:49152
    ds_read_b64_tr_b16 a[22:23], v10 offset:50176
    buffer_load_dwordx4 v14, s[24:27], s42 offen offset:1024 lds
    s_add_u32 s42, s42, 65536
    s_cmp_eq_u32 s42, s44
    s_cselect_b32 s42, s89, s42
    s_waitcnt vmcnt(22)
    s_barrier
    s_waitcnt lgkmcnt(6)
    v_mfma_f32_32x32x16_bf16 v[32:47], a[0:3], v[248:251], v[32:47]
    ds_read_b64_tr_b16 a[24:25], v5 offset:57344
    ds_read_b64_tr_b16 a[26:27], v5 offset:58368
    buffer_load_dwordx4 v[184:187], v2, s[32:35], s76 offen offset:2048 sc1
    buffer_load_dwordx4 v[188:191], v2, s[32:35], s76 offen offset:3072 sc1
    v_mfma_f32_32x32x16_bf16 v[48:63], a[4:7], v[248:251], v[48:63]
    ds_read_b64_tr_b16 a[28:29], v6 offset:57344
    ds_read_b64_tr_b16 a[30:31], v6 offset:58368
    s_waitcnt vmcnt(39)
    ds_read_b64_tr_b16 a[168:169], v3 offset:16384
    ds_read_b64_tr_b16 a[170:171], v3 offset:16896
    ds_read_b64_tr_b16 a[172:173], v4 offset:16384
    ds_read_b64_tr_b16 a[174:175], v4 offset:16896
    v_mfma_f32_32x32x16_bf16 v[64:79], a[8:11], v[248:251], v[64:79]
    ds_read_b64_tr_b16 a[32:33], v7 offset:57344
    ds_read_b64_tr_b16 a[34:35], v7 offset:58368
    s_waitcnt vmcnt(33)
    ds_read_b64_tr_b16 a[176:177], v3 offset:18432
    ds_read_b64_tr_b16 a[178:179], v3 offset:18944
    ds_read_b64_tr_b16 a[180:181], v4 offset:18432
    ds_read_b64_tr_b16 a[182:183], v4 offset:18944
    s_waitcnt lgkmcnt(14)
    v_mfma_f32_32x32x16_bf16 v[80:95], a[12:15], v[248:251], v[80:95]
    ds_read_b64_tr_b16 a[36:37], v8 offset:57344
    ds_read_b64_tr_b16 a[38:39], v8 offset:58368
    s_add_u32 m0, s91, 131072
    v_mfma_f32_32x32x16_bf16 v[96:111], a[16:19], v[248:251], v[96:111]
    ds_read_b64_tr_b16 a[40:41], v9 offset:57344
    ds_read_b64_tr_b16 a[42:43], v9 offset:58368
    buffer_load_dwordx4 v13, s[24:27], s42 offen lds
    v_mfma_f32_32x32x16_bf16 v[112:127], a[20:23], v[248:251], v[112:127]
    ds_read_b64_tr_b16 a[44:45], v10 offset:57344
    ds_read_b64_tr_b16 a[46:47], v10 offset:58368
    buffer_load_dwordx4 v14, s[24:27], s42 offen offset:1024 lds
    s_add_u32 s42, s42, 65536
    s_cmp_eq_u32 s42, s44
    s_cselect_b32 s42, s89, s42
    s_waitcnt lgkmcnt(10)
    v_mfma_f32_32x32x16_bf16 v[32:47], a[24:27], v[252:255], v[32:47]
    v_mfma_f32_32x32x16_bf16 v[48:63], a[28:31], v[252:255], v[48:63]
    s_waitcnt vmcnt(28)
    ds_read_b64_tr_b16 a[184:185], v3 offset:20480
    ds_read_b64_tr_b16 a[186:187], v3 offset:20992
    ds_read_b64_tr_b16 a[188:189], v4 offset:20480
    ds_read_b64_tr_b16 a[190:191], v4 offset:20992
    v_mfma_f32_32x32x16_bf16 v[64:79], a[32:35], v[252:255], v[64:79]
    s_waitcnt lgkmcnt(4)
    v_mfma_f32_32x32x16_bf16 v[80:95], a[36:39], v[252:255], v[80:95]
    s_add_u32 m0, s91, 139264
    v_mfma_f32_32x32x16_bf16 v[96:111], a[40:43], v[252:255], v[96:111]
    buffer_load_dwordx4 v13, s[24:27], s42 offen lds
    v_mfma_f32_32x32x16_bf16 v[112:127], a[44:47], v[252:255], v[112:127]
    buffer_load_dwordx4 v14, s[24:27], s42 offen offset:1024 lds
    s_add_u32 s42, s42, 65536
    s_cmp_eq_u32 s42, s44
    s_cselect_b32 s42, s89, s42
    v_max_f32 v32, 0, v32
    v_max_f32 v33, 0, v33
    v_max_f32 v34, 0, v34
    v_max_f32 v35, 0, v35
    v_max_f32 v36, 0, v36
    v_max_f32 v37, 0, v37
    v_max_f32 v38, 0, v38
    v_max_f32 v39, 0, v39
    v_pk_mul_f32 v[40:41], v[40:41], v[16:17] op_sel_hi:[1,0]
    v_pk_mul_f32 v[42:43], v[42:43], v[16:17] op_sel_hi:[1,0]
    v_pk_mul_f32 v[44:45], v[44:45], v[16:17] op_sel_hi:[1,0]
    v_pk_mul_f32 v[46:47], v[46:47], v[16:17] op_sel_hi:[1,0]
    v_pk_mul_f32 v[32:33], v[32:33], v[40:41]
    v_pk_mul_f32 v[34:35], v[34:35], v[42:43]
    v_pk_mul_f32 v[36:37], v[36:37], v[44:45]
    v_pk_mul_f32 v[38:39], v[38:39], v[46:47]
    v_cvt_pk_bf16_f32 v40, v32, v33
    v_cvt_pk_bf16_f32 v41, v34, v35
    v_cvt_pk_bf16_f32 v42, v36, v37
    v_cvt_pk_bf16_f32 v43, v38, v39
    s_add_u32 s72, s86, 0
    buffer_store_dwordx4 v[40:43], v2, s[32:35], s72 offen offset:0 sc1
    v_max_f32 v48, 0, v48
    v_max_f32 v49, 0, v49
    v_max_f32 v50, 0, v50
    v_max_f32 v51, 0, v51
    v_max_f32 v52, 0, v52
    v_max_f32 v53, 0, v53
    v_max_f32 v54, 0, v54
    v_max_f32 v55, 0, v55
    v_pk_mul_f32 v[56:57], v[56:57], v[16:17] op_sel_hi:[1,0]
    v_pk_mul_f32 v[58:59], v[58:59], v[16:17] op_sel_hi:[1,0]
    v_pk_mul_f32 v[60:61], v[60:61], v[16:17] op_sel_hi:[1,0]
    v_pk_mul_f32 v[62:63], v[62:63], v[16:17] op_sel_hi:[1,0]
    v_pk_mul_f32 v[48:49], v[48:49], v[56:57]
    v_pk_mul_f32 v[50:51], v[50:51], v[58:59]
    v_pk_mul_f32 v[52:53], v[52:53], v[60:61]
    v_pk_mul_f32 v[54:55], v[54:55], v[62:63]
    v_cvt_pk_bf16_f32 v56, v48, v49
    v_cvt_pk_bf16_f32 v57, v50, v51
    v_cvt_pk_bf16_f32 v58, v52, v53
    v_cvt_pk_bf16_f32 v59, v54, v55
    buffer_store_dwordx4 v[56:59], v2, s[32:35], s72 offen offset:1024 sc1
    v_max_f32 v64, 0, v64
    v_max_f32 v65, 0, v65
    v_max_f32 v66, 0, v66
    v_max_f32 v67, 0, v67
    v_max_f32 v68, 0, v68
    v_max_f32 v69, 0, v69
    v_max_f32 v70, 0, v70
    v_max_f32 v71, 0, v71
    v_pk_mul_f32 v[72:73], v[72:73], v[16:17] op_sel_hi:[1,0]
    v_pk_mul_f32 v[74:75], v[74:75], v[16:17] op_sel_hi:[1,0]
    v_pk_mul_f32 v[76:77], v[76:77], v[16:17] op_sel_hi:[1,0]
    v_pk_mul_f32 v[78:79], v[78:79], v[16:17] op_sel_hi:[1,0]
    v_pk_mul_f32 v[64:65], v[64:65], v[72:73]
    v_pk_mul_f32 v[66:67], v[66:67], v[74:75]
    v_pk_mul_f32 v[68:69], v[68:69], v[76:77]
    v_pk_mul_f32 v[70:71], v[70:71], v[78:79]
    v_cvt_pk_bf16_f32 v72, v64, v65
    v_cvt_pk_bf16_f32 v73, v66, v67
    v_cvt_pk_bf16_f32 v74, v68, v69
    v_cvt_pk_bf16_f32 v75, v70, v71
    buffer_store_dwordx4 v[72:75], v2, s[32:35], s72 offen offset:2048 sc1
    v_max_f32 v80, 0, v80
    v_max_f32 v81, 0, v81
    v_max_f32 v82, 0, v82
    v_max_f32 v83, 0, v83
    v_max_f32 v84, 0, v84
    v_max_f32 v85, 0, v85
    v_max_f32 v86, 0, v86
    v_max_f32 v87, 0, v87
    v_pk_mul_f32 v[88:89], v[88:89], v[16:17] op_sel_hi:[1,0]
    v_pk_mul_f32 v[90:91], v[90:91], v[16:17] op_sel_hi:[1,0]
    v_pk_mul_f32 v[92:93], v[92:93], v[16:17] op_sel_hi:[1,0]
    v_pk_mul_f32 v[94:95], v[94:95], v[16:17] op_sel_hi:[1,0]
    v_pk_mul_f32 v[80:81], v[80:81], v[88:89]
    v_pk_mul_f32 v[82:83], v[82:83], v[90:91]
    v_pk_mul_f32 v[84:85], v[84:85], v[92:93]
    v_pk_mul_f32 v[86:87], v[86:87], v[94:95]
    v_cvt_pk_bf16_f32 v88, v80, v81
    v_cvt_pk_bf16_f32 v89, v82, v83
    v_cvt_pk_bf16_f32 v90, v84, v85
    v_cvt_pk_bf16_f32 v91, v86, v87
    buffer_store_dwordx4 v[88:91], v2, s[32:35], s72 offen offset:3072 sc1
    v_max_f32 v96, 0, v96
    v_max_f32 v97, 0, v97
    v_max_f32 v98, 0, v98
    v_max_f32 v99, 0, v99
    v_max_f32 v100, 0, v100
    v_max_f32 v101, 0, v101
    v_max_f32 v102, 0, v102
    v_max_f32 v103, 0, v103
    v_pk_mul_f32 v[104:105], v[104:105], v[16:17] op_sel_hi:[1,0]
    v_pk_mul_f32 v[106:107], v[106:107], v[16:17] op_sel_hi:[1,0]
    v_pk_mul_f32 v[108:109], v[108:109], v[16:17] op_sel_hi:[1,0]
    v_pk_mul_f32 v[110:111], v[110:111], v[16:17] op_sel_hi:[1,0]
    v_pk_mul_f32 v[96:97], v[96:97], v[104:105]
    v_pk_mul_f32 v[98:99], v[98:99], v[106:107]
    v_pk_mul_f32 v[100:101], v[100:101], v[108:109]
    v_pk_mul_f32 v[102:103], v[102:103], v[110:111]
    v_cvt_pk_bf16_f32 v104, v96, v97
    v_cvt_pk_bf16_f32 v105, v98, v99
    v_cvt_pk_bf16_f32 v106, v100, v101
    v_cvt_pk_bf16_f32 v107, v102, v103
    s_cmp_lt_u32 s84, 3
    s_cbranch_scc1 L_skip5
    s_add_u32 s72, s86, 4096
    buffer_store_dwordx4 v[104:107], v2, s[32:35], s72 offen offset:0 sc1
    v_max_f32 v112, 0, v112
    v_max_f32 v113, 0, v113
    v_max_f32 v114, 0, v114
    v_max_f32 v115, 0, v115
    v_max_f32 v116, 0, v116
    v_max_f32 v117, 0, v117
    v_max_f32 v118, 0, v118
    v_max_f32 v119, 0, v119
    v_pk_mul_f32 v[120:121], v[120:121], v[16:17] op_sel_hi:[1,0]
    v_pk_mul_f32 v[122:123], v[122:123], v[16:17] op_sel_hi:[1,0]
    v_pk_mul_f32 v[124:125], v[124:125], v[16:17] op_sel_hi:[1,0]
    v_pk_mul_f32 v[126:127], v[126:127], v[16:17] op_sel_hi:[1,0]
    v_pk_mul_f32 v[112:113], v[112:113], v[120:121]
    v_pk_mul_f32 v[114:115], v[114:115], v[122:123]
    v_pk_mul_f32 v[116:117], v[116:117], v[124:125]
    v_pk_mul_f32 v[118:119], v[118:119], v[126:127]
    v_cvt_pk_bf16_f32 v120, v112, v113
    v_cvt_pk_bf16_f32 v121, v114, v115
    v_cvt_pk_bf16_f32 v122, v116, v117
    v_cvt_pk_bf16_f32 v123, v118, v119
    buffer_store_dwordx4 v[120:123], v2, s[32:35], s72 offen offset:1024 sc1
L_skip5:
    s_barrier
    s_waitcnt lgkmcnt(0)
    v_subrev_u32 v5, s90, v3
    v_add_u32 v5, s91, v5
    v_add_u32 v5, 98304, v5
    v_xor_b32 v6, 64, v5
    v_add_u32 v8, 120832, v2
    v_mfma_f32_32x32x16_bf16 v[32:47], a[48:51], a[64:67], 0
    v_mfma_f32_32x32x16_bf16 v[32:47], a[52:55], a[68:71], v[32:47]
    s_and_b32 s76, s68, 1
    s_lshl_b32 s76, s76, 1
    s_nop 9
    v_max3_f32 v26, v32, v33, v34
    v_min3_f32 v27, v32, v33, v34
    v_max3_f32 v26, v26, v35, v36
    v_min3_f32 v27, v27, v35, v36
    v_max3_f32 v26, v26, v37, v38
    v_min3_f32 v27, v27, v37, v38
    v_max3_f32 v26, v26, v39, v40
    s_lshr_b32 s77, s68, 1
    s_add_u32 s76, s76, s77
    s_add_u32 m0, s91, 147456
    s_nop 0
    buffer_load_dwordx4 v13, s[24:27], s42 offen lds
    buffer_load_dwordx4 v14, s[24:27], s42 offen offset:1024 lds
    s_add_u32 s42, s42, 65536
    s_cmp_eq_u32 s42, s44
    s_cselect_b32 s42, s89, s42
    v_min3_f32 v27, v27, v39, v40
    v_max3_f32 v26, v26, v41, v42
    v_min3_f32 v27, v27, v41, v42
    v_max3_f32 v26, v26, v43, v44
    v_min3_f32 v27, v27, v43, v44
    v_max3_f32 v26, v26, v45, v46
    v_min3_f32 v27, v27, v45, v46
    s_lshl_b32 s76, s76, 10
    s_add_u32 s76, s76, 90112
    v_max_f32 v26, v26, v47
    v_min_f32 v27, v27, v47
    v_mul_f32 v26, v15, v26
    v_mul_f32 v27, v15, v27
    v_fma_f32 v48, -v32, v15, v27
    v_fma_f32 v32, v32, v15, -v26
    v_fma_f32 v49, -v33, v15, v27
    v_add_u32 v22, s76, v2
    v_mov_b32 v240, 0x3f803f80
    v_fma_f32 v33, v33, v15, -v26
    v_fma_f32 v50, -v34, v15, v27
    v_fma_f32 v34, v34, v15, -v26
    v_fma_f32 v51, -v35, v15, v27
    v_fma_f32 v35, v35, v15, -v26
    v_fma_f32 v52, -v36, v15, v27
    v_fma_f32 v36, v36, v15, -v26
    v_mov_b32 v241, 0x3f803f80
    v_mov_b32 v242, 0x3f803f80
    s_add_u32 m0, s91, 155648
    s_nop 0
    buffer_load_dwordx4 v13, s[24:27], s42 offen lds
    buffer_load_dwordx4 v14, s[24:27], s42 offen offset:1024 lds
    s_add_u32 s42, s42, 65536
    s_cmp_eq_u32 s42, s44
    s_cselect_b32 s42, s89, s42
    v_fma_f32 v53, -v37, v15, v27
    v_fma_f32 v37, v37, v15, -v26
    v_fma_f32 v54, -v38, v15, v27
    v_fma_f32 v38, v38, v15, -v26
    v_fma_f32 v55, -v39, v15, v27
    v_fma_f32 v39, v39, v15, -v26
    v_fma_f32 v56, -v40, v15, v27
    v_mov_b32 v243, 0x3f803f80
    v_mov_b32 v23, 94208
    v_fma_f32 v40, v40, v15, -v26
    v_fma_f32 v57, -v41, v15, v27
    v_fma_f32 v41, v41, v15, -v26
    v_fma_f32 v58, -v42, v15, v27
    v_fma_f32 v42, v42, v15, -v26
    v_fma_f32 v59, -v43, v15, v27
    v_fma_f32 v43, v43, v15, -v26
    ds_write_b128 v23, v[240:243]
    s_waitcnt vmcnt(30)
    v_fma_f32 v60, -v44, v15, v27
    v_fma_f32 v44, v44, v15, -v26
    v_fma_f32 v61, -v45, v15, v27
    v_fma_f32 v45, v45, v15, -v26
    v_fma_f32 v62, -v46, v15, v27
    v_fma_f32 v46, v46, v15, -v26
    v_fma_f32 v63, -v47, v15, v27
    v_mfma_f32_32x32x16_bf16 v[192:207], a[56:59], v[128:131], 0
    s_add_u32 m0, s90, 0
    s_nop 0
    buffer_load_dwordx4 v13, s[24:27], s42 offen lds
    buffer_load_dwordx4 v14, s[24:27], s42 offen offset:1024 lds
    s_add_u32 s42, s42, 65536
    s_cmp_eq_u32 s42, s44
    s_cselect_b32 s42, s89, s42
    v_fma_f32 v47, v47, v15, -v26
    v_exp_f32 v32, v32
    v_exp_f32 v48, v48
    v_exp_f32 v33, v33
    v_mfma_f32_32x32x16_bf16 v[192:207], a[56:59], v[132:135], v[192:207]
    v_exp_f32 v49, v49
    v_exp_f32 v34, v34
    v_exp_f32 v50, v50
    v_exp_f32 v35, v35
    v_mfma_f32_32x32x16_bf16 v[192:207], a[56:59], v[136:139], v[192:207]
    v_exp_f32 v51, v51
    v_exp_f32 v36, v36
    v_exp_f32 v52, v52
    v_exp_f32 v37, v37
    v_mfma_f32_32x32x16_bf16 v[192:207], a[56:59], v[140:143], v[192:207]
    s_add_u32 m0, s90, 2048
    s_nop 0
    buffer_load_dwordx4 v13, s[24:27], s42 offen lds
    buffer_load_dwordx4 v14, s[24:27], s42 offen offset:1024 lds
    s_add_u32 s42, s42, 65536
    s_cmp_eq_u32 s42, s44
    s_cselect_b32 s42, s89, s42
    v_exp_f32 v53, v53
    v_exp_f32 v38, v38
    v_exp_f32 v54, v54
    v_exp_f32 v39, v39
    s_waitcnt vmcnt(28)
    v_mfma_f32_32x32x16_bf16 v[192:207], a[56:59], v[144:147], v[192:207]
    v_exp_f32 v55, v55
    v_exp_f32 v40, v40
    v_exp_f32 v56, v56
    v_exp_f32 v41, v41
    v_mfma_f32_32x32x16_bf16 v[192:207], a[56:59], v[148:151], v[192:207]
    v_exp_f32 v57, v57
    v_exp_f32 v42, v42
    v_exp_f32 v58, v58
    v_exp_f32 v43, v43
    v_mfma_f32_32x32x16_bf16 v[192:207], a[56:59], v[152:155], v[192:207]
    s_add_u32 m0, s90, 4096
    s_nop 0
    buffer_load_dwordx4 v13, s[24:27], s42 offen lds
    buffer_load_dwordx4 v14, s[24:27], s42 offen offset:1024 lds
    s_add_u32 s42, s42, 65536
    s_cmp_eq_u32 s42, s44
    s_cselect_b32 s42, s89, s42
    v_exp_f32 v59, v59
    v_exp_f32 v44, v44
    v_exp_f32 v60, v60
    v_exp_f32 v45, v45
    s_waitcnt vmcnt(10)
    s_barrier
    s_cmp_lg_u32 s68, 0
    s_cbranch_scc1 L_fh
    s_lshl_b32 s72, s69, 7
    s_lshl_b32 s73, s70, 2
    s_add_u32 s72, s72, s73
    s_add_u32 s72, s72, 8192
    v_mov_b32 v30, s71
    s_mov_b64 exec, 1
    buffer_store_dword v30, off, s[32:35], s72 sc1
    s_mov_b64 exec, -1
L_fh:
    v_mfma_f32_32x32x16_bf16 v[192:207], a[56:59], v[156:159], v[192:207]
    v_exp_f32 v61, v61
    v_exp_f32 v46, v46
    v_exp_f32 v62, v62
    v_exp_f32 v47, v47
    s_waitcnt vmcnt(24)
    v_mfma_f32_32x32x16_bf16 v[192:207], a[56:59], v[160:163], v[192:207]
    v_exp_f32 v63, v63
    v_cvt_pk_bf16_f32 v64, v32, v33
    v_cvt_pk_bf16_f32 v72, v48, v49
    v_cvt_pk_bf16_f32 v65, v34, v35
    v_cvt_pk_bf16_f32 v73, v50, v51
    v_cvt_pk_bf16_f32 v66, v36, v37
    v_mfma_f32_32x32x16_bf16 v[192:207], a[56:59], v[164:167], v[192:207]
    s_add_u32 m0, s90, 6144
    s_nop 0
    buffer_load_dwordx4 v13, s[20:23], s45 offen lds
    buffer_load_dwordx4 v14, s[20:23], s45 offen offset:1024 lds
    s_add_u32 s45, s45, 65536
    s_and_b32 s45, s45, 0x7ffff
    v_cvt_pk_bf16_f32 v74, v52, v53
    v_cvt_pk_bf16_f32 v67, v38, v39
    v_cvt_pk_bf16_f32 v75, v54, v55
    v_cvt_pk_bf16_f32 v68, v40, v41
    v_cvt_pk_bf16_f32 v76, v56, v57
    v_cvt_pk_bf16_f32 v69, v42, v43
    v_cvt_pk_bf16_f32 v77, v58, v59
    v_mfma_f32_32x32x16_bf16 v[192:207], a[56:59], v[168:171], v[192:207]
    v_cvt_pk_bf16_f32 v70, v44, v45
    v_cvt_pk_bf16_f32 v78, v60, v61
    v_cvt_pk_bf16_f32 v71, v46, v47
    v_cvt_pk_bf16_f32 v79, v62, v63
    v_permlane32_swap_b32 v64, v68
    v_permlane32_swap_b32 v65, v69
    v_permlane32_swap_b32 v66, v70
    v_mfma_f32_32x32x16_bf16 v[192:207], a[56:59], v[172:175], v[192:207]
    v_permlane32_swap_b32 v67, v71
    v_permlane32_swap_b32 v72, v76
    v_permlane32_swap_b32 v73, v77
    v_permlane32_swap_b32 v74, v78
    v_permlane32_swap_b32 v75, v79
    s_waitcnt vmcnt(20)
    v_mfma_f32_32x32x16_bf16 v[192:207], a[56:59], v[176:179], v[192:207]
    s_add_u32 m0, s90, 8192
    s_nop 0
    buffer_load_dwordx4 v13, s[20:23], s45 offen lds
    buffer_load_dwordx4 v14, s[20:23], s45 offen offset:1024 lds
    s_add_u32 s45, s45, 65536
    s_and_b32 s45, s45, 0x7ffff
    v_mfma_f32_32x32x16_bf16 v[192:207], a[56:59], v[180:183], v[192:207]
    v_mfma_f32_32x32x16_bf16 v[192:207], a[56:59], v[184:187], v[192:207]
    v_mfma_f32_32x32x16_bf16 v[192:207], a[56:59], v[188:191], v[192:207]
    s_add_u32 m0, s90, 10240
    s_nop 0
    buffer_load_dwordx4 v13, s[20:23], s45 offen lds
    buffer_load_dwordx4 v14, s[20:23], s45 offen offset:1024 lds
    s_add_u32 s45, s45, 65536
    s_and_b32 s45, s45, 0x7ffff
    s_nop 5
    v_cvt_pk_bf16_f32 v18, v192, v193
    v_cvt_pk_bf16_f32 v19, v194, v195
    v_cvt_pk_bf16_f32 v20, v196, v197
    v_cvt_pk_bf16_f32 v21, v198, v199
    ds_write_b128 v22, v[18:21]
    s_waitcnt lgkmcnt(0)
    s_barrier
    v_and_b32 v18, 27, v1
    v_mov_b32 v20, 94208
    v_cmp_eq_u32 vcc, 17, v18
    v_add_u32 v22, 90112, v2
    s_nop 0
    v_cndmask_b32 v22, v22, v20, vcc
    ds_read_b128 v[208:211], v22
    v_add_u32 v23, 91136, v2
    v_cndmask_b32 v23, v23, v20, vcc
    ds_read_b128 v[212:215], v23
    v_add_u32 v24, 92160, v2
    v_cndmask_b32 v24, v24, v20, vcc
    ds_read_b128 v[216:219], v24
    v_add_u32 v25, 93184, v2
    v_cndmask_b32 v25, v25, v20, vcc
    ds_read_b128 v[220:223], v25
    s_lshr_b32 s41, s87, 1
    s_lshl_b32 s41, s41, 7
    s_add_u32 s41, s41, 8192
    v_and_b32 v28, 15, v1
    v_lshlrev_b32 v28, 2, v28
    buffer_load_dword v29, v28, s[32:35], s41 offen sc1
    s_waitcnt lgkmcnt(0)
    v_mfma_f32_32x32x16_bf16 v[128:143], v[208:211], v[64:67], 0
    v_mfma_f32_32x32x16_bf16 v[144:159], v[212:215], v[72:75], 0
    v_mfma_f32_32x32x16_bf16 v[160:175], v[216:219], v[68:71], 0
    v_mfma_f32_32x32x16_bf16 v[176:191], v[220:223], v[76:79], 0
    s_add_u32 m0, s90, 12288
    s_nop 0
    buffer_load_dwordx4 v13, s[20:23], s45 offen lds
    buffer_load_dwordx4 v14, s[20:23], s45 offen offset:1024 lds
    s_add_u32 s45, s45, 65536
    s_and_b32 s45, s45, 0x7ffff
    s_add_u32 m0, s90, 14336
    s_nop 0
    buffer_load_dwordx4 v13, s[20:23], s45 offen lds
    buffer_load_dwordx4 v14, s[20:23], s45 offen offset:1024 lds
    s_add_u32 s45, s45, 65536
    s_and_b32 s45, s45, 0x7ffff
    s_lshl_b32 s76, s70, 1
    s_add_u32 s76, s76, s85
    s_add_u32 s76, s76, 86
    s_lshl_b32 s76, s76, 10
    s_add_u32 s76, s76, 2097152
    v_mov_b32 v20, 0x358637bd
    v_mul_f32 v18, v136, v153
    v_fma_f32 v18, v152, v137, v18
    v_mul_f32 v19, v137, v153
    v_fma_f32 v18, v19, v20, v18
    v_rcp_f32 v18, v18
    s_nop 0
    v_mul_f32 v22, v153, v18
    v_mul_f32 v24, v137, v18
    v_pk_mul_f32 v[128:129], v[128:129], v[22:23] op_sel_hi:[1,0]
    v_pk_mul_f32 v[130:131], v[130:131], v[22:23] op_sel_hi:[1,0]
    v_pk_mul_f32 v[132:133], v[132:133], v[22:23] op_sel_hi:[1,0]
    v_pk_mul_f32 v[134:135], v[134:135], v[22:23] op_sel_hi:[1,0]
    v_pk_fma_f32 v[128:129], v[144:145], v[24:25], v[128:129] op_sel_hi:[1,0,1]
    v_pk_fma_f32 v[130:131], v[146:147], v[24:25], v[130:131] op_sel_hi:[1,0,1]
    v_pk_fma_f32 v[132:133], v[148:149], v[24:25], v[132:133] op_sel_hi:[1,0,1]
    v_pk_fma_f32 v[134:135], v[150:151], v[24:25], v[134:135] op_sel_hi:[1,0,1]
    v_cvt_pk_bf16_f32 v224, v128, v129
    v_cvt_pk_bf16_f32 v225, v130, v131
    v_cvt_pk_bf16_f32 v226, v132, v133
    v_cvt_pk_bf16_f32 v227, v134, v135
    buffer_store_dwordx4 v[224:227], v2, s[32:35], s76 offen sc1
    s_lshl_b32 s76, s70, 1
    s_add_u32 s76, s76, s85
    s_add_u32 s76, s76, 87
    s_lshl_b32 s76, s76, 10
    s_add_u32 s76, s76, 2097152
    v_mov_b32 v20, 0x358637bd
    v_mul_f32 v18, v168, v185
    v_fma_f32 v18, v184, v169, v18
    v_mul_f32 v19, v169, v185
    v_fma_f32 v18, v19, v20, v18
    v_rcp_f32 v18, v18
    s_nop 0
    v_mul_f32 v22, v185, v18
    v_mul_f32 v24, v169, v18
    v_pk_mul_f32 v[160:161], v[160:161], v[22:23] op_sel_hi:[1,0]
    v_pk_mul_f32 v[162:163], v[162:163], v[22:23] op_sel_hi:[1,0]
    v_pk_mul_f32 v[164:165], v[164:165], v[22:23] op_sel_hi:[1,0]
    v_pk_mul_f32 v[166:167], v[166:167], v[22:23] op_sel_hi:[1,0]
    v_pk_fma_f32 v[160:161], v[176:177], v[24:25], v[160:161] op_sel_hi:[1,0,1]
    v_pk_fma_f32 v[162:163], v[178:179], v[24:25], v[162:163] op_sel_hi:[1,0,1]
    v_pk_fma_f32 v[164:165], v[180:181], v[24:25], v[164:165] op_sel_hi:[1,0,1]
    v_pk_fma_f32 v[166:167], v[182:183], v[24:25], v[166:167] op_sel_hi:[1,0,1]
    v_cvt_pk_bf16_f32 v228, v160, v161
    v_cvt_pk_bf16_f32 v229, v162, v163
    v_cvt_pk_bf16_f32 v230, v164, v165
    v_cvt_pk_bf16_f32 v231, v166, v167
    buffer_store_dwordx4 v[228:231], v2, s[32:35], s76 offen sc1
    s_add_u32 m0, s90, 16384
    s_nop 0
    buffer_load_dwordx4 v13, s[20:23], s45 offen lds
    buffer_load_dwordx4 v14, s[20:23], s45 offen offset:1024 lds
    s_add_u32 s45, s45, 65536
    s_and_b32 s45, s45, 0x7ffff
    s_add_u32 m0, s90, 18432
    s_nop 0
    buffer_load_dwordx4 v13, s[20:23], s45 offen lds
    buffer_load_dwordx4 v14, s[20:23], s45 offen offset:1024 lds
    s_add_u32 s45, s45, 65536
    s_and_b32 s45, s45, 0x7ffff
    s_add_u32 m0, s90, 20480
    s_nop 0
    buffer_load_dwordx4 v13, s[20:23], s45 offen lds
    buffer_load_dwordx4 v14, s[20:23], s45 offen offset:1024 lds
    s_add_u32 s45, s45, 65536
    s_and_b32 s45, s45, 0x7ffff
    v_and_b32 v18, 31, v1
    s_and_b32 s72, s68, 1
    s_lshl_b32 s72, s72, 5
    s_lshl_b32 s73, s87, 6
    s_add_u32 s72, s72, s73
    v_add_u32 v18, s72, v18
    v_lshlrev_b32 v18, 10, v18
    v_lshrrev_b32 v19, 5, v1
    v_lshl_add_u32 v18, v19, 4, v18
    s_lshr_b32 s72, s68, 1
    s_lshl_b32 s72, s72, 6
    s_lshl_b32 s73, s88, 7
    s_add_u32 s72, s72, s73
    v_add_u32 v7, s72, v18
    s_add_u32 s64, s92, 86016
    s_cmp_ge_u32 s68, 2
    s_cselect_b32 s65, 0x7f000000, s64
    s_waitcnt vmcnt(12)
    s_mov_b32 s94, 0
L_ph_loop:
    v_cmp_ne_u32 vcc, s71, v29
    s_nop 4
    s_cmp_eq_u64 vcc, 0
    s_cbranch_scc1 L_ph_done
    buffer_load_dword v29, v28, s[32:35], s41 offen sc1
    s_add_u32 s94, s94, 1
    s_waitcnt vmcnt(0)
    s_cmp_lt_u32 s94, 200000
    s_cbranch_scc1 L_ph_loop
L_ph_done:
    s_cmp_eq_u32 s46, s64
    s_cselect_b32 s73, s65, s46
    buffer_load_dwordx4 v[128:131], v2, s[32:35], s73 offen sc1
    buffer_load_dwordx4 v[132:135], v8, s[32:35], s73 offen sc1
    s_add_u32 s46, s46, 4096
    s_cmp_eq_u32 s46, s93
    s_cselect_b32 s46, s92, s46
    s_cmp_eq_u32 s46, s64
    s_cselect_b32 s73, s65, s46
    buffer_load_dwordx4 v[136:139], v2, s[32:35], s73 offen sc1
    buffer_load_dwordx4 v[140:143], v8, s[32:35], s73 offen sc1
    s_add_u32 s46, s46, 4096
    s_cmp_eq_u32 s46, s93
    s_cselect_b32 s46, s92, s46
    s_cmp_eq_u32 s46, s64
    s_cselect_b32 s73, s65, s46
    buffer_load_dwordx4 v[144:147], v2, s[32:35], s73 offen sc1
    buffer_load_dwordx4 v[148:151], v8, s[32:35], s73 offen sc1
    s_add_u32 s46, s46, 4096
    s_cmp_eq_u32 s46, s93
    s_cselect_b32 s46, s92, s46
    s_cmp_eq_u32 s46, s64
    s_cselect_b32 s73, s65, s46
    buffer_load_dwordx4 v[152:155], v2, s[32:35], s73 offen sc1
    buffer_load_dwordx4 v[156:159], v8, s[32:35], s73 offen sc1
    s_add_u32 s46, s46, 4096
    s_cmp_eq_u32 s46, s93
    s_cselect_b32 s46, s92, s46
    s_cmp_eq_u32 s46, s64
    s_cselect_b32 s73, s65, s46
    buffer_load_dwordx4 v[160:163], v2, s[32:35], s73 offen sc1
    buffer_load_dwordx4 v[164:167], v8, s[32:35], s73 offen sc1
    s_add_u32 s46, s46, 4096
    s_cmp_eq_u32 s46, s93
    s_cselect_b32 s46, s92, s46
    s_cmp_eq_u32 s46, s64
    s_cselect_b32 s73, s65, s46
    buffer_load_dwordx4 v[168:171], v2, s[32:35], s73 offen sc1
    buffer_load_dwordx4 v[172:175], v8, s[32:35], s73 offen sc1
    s_add_u32 s46, s46, 4096
    s_cmp_eq_u32 s46, s93
    s_cselect_b32 s46, s92, s46
    s_cmp_eq_u32 s46, s64
    s_cselect_b32 s73, s65, s46
    buffer_load_dwordx4 v[176:179], v2, s[32:35], s73 offen sc1
    buffer_load_dwordx4 v[180:183], v8, s[32:35], s73 offen sc1
    s_add_u32 s46, s46, 4096
    s_cmp_eq_u32 s46, s93
    s_cselect_b32 s46, s92, s46
    s_cmp_eq_u32 s46, s64
    s_cselect_b32 s73, s65, s46
    buffer_load_dwordx4 v[184:187], v2, s[32:35], s73 offen sc1
    buffer_load_dwordx4 v[188:191], v8, s[32:35], s73 offen sc1
    s_add_u32 s46, s46, 4096
    s_cmp_eq_u32 s46, s93
    s_cselect_b32 s46, s92, s46
    buffer_load_dwordx4 v[232:235], v7, s[8:11], 0 offen
    buffer_load_dwordx4 v[236:239], v7, s[8:11], 0 offen offset:32
    s_waitcnt vmcnt(16)
    v_mfma_f32_32x32x16_bf16 v[32:47], a[104:107], v[128:131], 0
    v_mfma_f32_32x32x16_bf16 v[48:63], a[104:107], v[132:135], 0
    v_mfma_f32_32x32x16_bf16 v[64:79], a[108:111], v[128:131], 0
    v_mfma_f32_32x32x16_bf16 v[80:95], a[108:111], v[132:135], 0
    s_cmp_eq_u32 s46, s64
    s_cselect_b32 s73, s65, s46
    buffer_load_dwordx4 v[128:131], v2, s[32:35], s73 offen sc1
    buffer_load_dwordx4 v[132:135], v8, s[32:35], s73 offen sc1
    s_add_u32 s46, s46, 4096
    s_cmp_eq_u32 s46, s93
    s_cselect_b32 s46, s92, s46
    s_waitcnt vmcnt(26)
    s_barrier
    s_cmp_lg_u32 s68, 0
    s_cbranch_scc1 L_fo
    s_lshl_b32 s72, s69, 7
    s_lshl_b32 s73, s70, 2
    s_add_u32 s72, s72, s73
    s_add_u32 s72, s72, 12288
    v_mov_b32 v30, s71
    s_mov_b64 exec, 1
    buffer_store_dword v30, off, s[32:35], s72 sc1
    s_mov_b64 exec, -1
L_fo:
    s_waitcnt vmcnt(16)
    v_mfma_f32_32x32x16_bf16 v[32:47], a[112:115], v[136:139], v[32:47]
    v_mfma_f32_32x32x16_bf16 v[48:63], a[112:115], v[140:143], v[48:63]
    v_mfma_f32_32x32x16_bf16 v[64:79], a[116:119], v[136:139], v[64:79]
    v_mfma_f32_32x32x16_bf16 v[80:95], a[116:119], v[140:143], v[80:95]
    s_cmp_eq_u32 s46, s64
    s_cselect_b32 s73, s65, s46
    buffer_load_dwordx4 v[136:139], v2, s[32:35], s73 offen sc1
    buffer_load_dwordx4 v[140:143], v8, s[32:35], s73 offen sc1
    s_add_u32 s46, s46, 4096
    s_cmp_eq_u32 s46, s93
    s_cselect_b32 s46, s92, s46
    s_waitcnt vmcnt(16)
    v_mfma_f32_32x32x16_bf16 v[32:47], a[120:123], v[144:147], v[32:47]
    v_mfma_f32_32x32x16_bf16 v[48:63], a[120:123], v[148:151], v[48:63]
    v_mfma_f32_32x32x16_bf16 v[64:79], a[124:127], v[144:147], v[64:79]
    v_mfma_f32_32x32x16_bf16 v[80:95], a[124:127], v[148:151], v[80:95]
    s_cmp_eq_u32 s46, s64
    s_cselect_b32 s73, s65, s46
    buffer_load_dwordx4 v[144:147], v2, s[32:35], s73 offen sc1
    buffer_load_dwordx4 v[148:151], v8, s[32:35], s73 offen sc1
    s_add_u32 s46, s46, 4096
    s_cmp_eq_u32 s46, s93
    s_cselect_b32 s46, s92, s46
    s_waitcnt vmcnt(16)
    v_mfma_f32_32x32x16_bf16 v[32:47], a[128:131], v[152:155], v[32:47]
    v_mfma_f32_32x32x16_bf16 v[48:63], a[128:131], v[156:159], v[48:63]
    v_mfma_f32_32x32x16_bf16 v[64:79], a[132:135], v[152:155], v[64:79]
    v_mfma_f32_32x32x16_bf16 v[80:95], a[132:135], v[156:159], v[80:95]
    s_cmp_eq_u32 s46, s64
    s_cselect_b32 s73, s65, s46
    buffer_load_dwordx4 v[152:155], v2, s[32:35], s73 offen sc1
    buffer_load_dwordx4 v[156:159], v8, s[32:35], s73 offen sc1
    s_add_u32 s46, s46, 4096
    s_cmp_eq_u32 s46, s93
    s_cselect_b32 s46, s92, s46
    s_waitcnt vmcnt(16)
    v_mfma_f32_32x32x16_bf16 v[32:47], a[136:139], v[160:163], v[32:47]
    v_mfma_f32_32x32x16_bf16 v[48:63], a[136:139], v[164:167], v[48:63]
    v_mfma_f32_32x32x16_bf16 v[64:79], a[140:143], v[160:163], v[64:79]
    v_mfma_f32_32x32x16_bf16 v[80:95], a[140:143], v[164:167], v[80:95]
    s_cmp_eq_u32 s46, s64
    s_cselect_b32 s73, s65, s46
    buffer_load_dwordx4 v[160:163], v2, s[32:35], s73 offen sc1
    buffer_load_dwordx4 v[164:167], v8, s[32:35], s73 offen sc1
    s_add_u32 s46, s46, 4096
    s_cmp_eq_u32 s46, s93
    s_cselect_b32 s46, s92, s46
    s_waitcnt vmcnt(16)
    v_mfma_f32_32x32x16_bf16 v[32:47], a[144:147], v[168:171], v[32:47]
    v_mfma_f32_32x32x16_bf16 v[48:63], a[144:147], v[172:175], v[48:63]
    v_mfma_f32_32x32x16_bf16 v[64:79], a[148:151], v[168:171], v[64:79]
    v_mfma_f32_32x32x16_bf16 v[80:95], a[148:151], v[172:175], v[80:95]
    s_cmp_eq_u32 s46, s64
    s_cselect_b32 s73, s65, s46
    buffer_load_dwordx4 v[168:171], v2, s[32:35], s73 offen sc1
    buffer_load_dwordx4 v[172:175], v8, s[32:35], s73 offen sc1
    s_add_u32 s46, s46, 4096
    s_cmp_eq_u32 s46, s93
    s_cselect_b32 s46, s92, s46
    s_waitcnt vmcnt(16)
    v_mfma_f32_32x32x16_bf16 v[32:47], a[152:155], v[176:179], v[32:47]
    v_mfma_f32_32x32x16_bf16 v[48:63], a[152:155], v[180:183], v[48:63]
    v_mfma_f32_32x32x16_bf16 v[64:79], a[156:159], v[176:179], v[64:79]
    v_mfma_f32_32x32x16_bf16 v[80:95], a[156:159], v[180:183], v[80:95]
    s_cmp_eq_u32 s46, s64
    s_cselect_b32 s73, s65, s46
    buffer_load_dwordx4 v[176:179], v2, s[32:35], s73 offen sc1
    buffer_load_dwordx4 v[180:183], v8, s[32:35], s73 offen sc1
    s_add_u32 s46, s46, 4096
    s_cmp_eq_u32 s46, s93
    s_cselect_b32 s46, s92, s46
    s_waitcnt vmcnt(16)
    v_mfma_f32_32x32x16_bf16 v[32:47], a[160:163], v[184:187], v[32:47]
    v_mfma_f32_32x32x16_bf16 v[48:63], a[160:163], v[188:191], v[48:63]
    v_mfma_f32_32x32x16_bf16 v[64:79], a[164:167], v[184:187], v[64:79]
    v_mfma_f32_32x32x16_bf16 v[80:95], a[164:167], v[188:191], v[80:95]
    s_cmp_eq_u32 s46, s64
    s_cselect_b32 s73, s65, s46
    buffer_load_dwordx4 v[184:187], v2, s[32:35], s73 offen sc1
    buffer_load_dwordx4 v[188:191], v8, s[32:35], s73 offen sc1
    s_add_u32 s46, s46, 4096
    s_cmp_eq_u32 s46, s93
    s_cselect_b32 s46, s92, s46
    s_waitcnt vmcnt(14)
    v_mfma_f32_32x32x16_bf16 v[32:47], a[168:171], v[128:131], v[32:47]
    v_mfma_f32_32x32x16_bf16 v[48:63], a[168:171], v[132:135], v[48:63]
    v_mfma_f32_32x32x16_bf16 v[64:79], a[172:175], v[128:131], v[64:79]
    v_mfma_f32_32x32x16_bf16 v[80:95], a[172:175], v[132:135], v[80:95]
    s_cmp_eq_u32 s46, s64
    s_cselect_b32 s73, s65, s46
    buffer_load_dwordx4 v[128:131], v2, s[32:35], s73 offen sc1
    buffer_load_dwordx4 v[132:135], v8, s[32:35], s73 offen sc1
    s_add_u32 s46, s46, 4096
    s_cmp_eq_u32 s46, s93
    s_cselect_b32 s46, s92, s46
    s_lshr_b32 s41, s87, 1
    s_lshl_b32 s41, s41, 7
    s_add_u32 s41, s41, 12288
    v_and_b32 v28, 15, v1
    v_lshlrev_b32 v28, 2, v28
    buffer_load_dword v29, v28, s[32:35], s41 offen sc1
    s_waitcnt vmcnt(15)
    v_mfma_f32_32x32x16_bf16 v[32:47], a[176:179], v[136:139], v[32:47]
    v_mfma_f32_32x32x16_bf16 v[48:63], a[176:179], v[140:143], v[48:63]
    v_mfma_f32_32x32x16_bf16 v[64:79], a[180:183], v[136:139], v[64:79]
    v_mfma_f32_32x32x16_bf16 v[80:95], a[180:183], v[140:143], v[80:95]
    s_cmp_eq_u32 s46, s64
    s_cselect_b32 s73, s65, s46
    buffer_load_dwordx4 v[136:139], v2, s[32:35], s73 offen sc1
    buffer_load_dwordx4 v[140:143], v8, s[32:35], s73 offen sc1
    s_add_u32 s46, s46, 4096
    s_cmp_eq_u32 s46, s93
    s_cselect_b32 s46, s92, s46
    s_waitcnt vmcnt(63)
    ds_read_b64_tr_b16 a[200:201], v5 offset:0
    ds_read_b64_tr_b16 a[202:203], v5 offset:512
    ds_read_b64_tr_b16 a[204:205], v6 offset:0
    ds_read_b64_tr_b16 a[206:207], v6 offset:512
    s_waitcnt vmcnt(15)
    v_mfma_f32_32x32x16_bf16 v[32:47], a[184:187], v[144:147], v[32:47]
    v_mfma_f32_32x32x16_bf16 v[48:63], a[184:187], v[148:151], v[48:63]
    v_mfma_f32_32x32x16_bf16 v[64:79], a[188:191], v[144:147], v[64:79]
    v_mfma_f32_32x32x16_bf16 v[80:95], a[188:191], v[148:151], v[80:95]
    s_cmp_eq_u32 s46, s64
    s_cselect_b32 s73, s65, s46
    buffer_load_dwordx4 v[144:147], v2, s[32:35], s73 offen sc1
    buffer_load_dwordx4 v[148:151], v8, s[32:35], s73 offen sc1
    s_add_u32 s46, s46, 4096
    s_cmp_eq_u32 s46, s93
    s_cselect_b32 s46, s92, s46
    s_waitcnt vmcnt(63)
    ds_read_b64_tr_b16 a[192:193], v5 offset:8192
    ds_read_b64_tr_b16 a[194:195], v5 offset:8704
    ds_read_b64_tr_b16 a[196:197], v6 offset:8192
    ds_read_b64_tr_b16 a[198:199], v6 offset:8704
    s_waitcnt vmcnt(15) lgkmcnt(4)
    v_mfma_f32_32x32x16_bf16 v[32:47], a[200:203], v[152:155], v[32:47]
    v_mfma_f32_32x32x16_bf16 v[48:63], a[200:203], v[156:159], v[48:63]
    v_mfma_f32_32x32x16_bf16 v[64:79], a[204:207], v[152:155], v[64:79]
    v_mfma_f32_32x32x16_bf16 v[80:95], a[204:207], v[156:159], v[80:95]
    s_cmp_eq_u32 s46, s64
    s_cselect_b32 s73, s65, s46
    buffer_load_dwordx4 v[152:155], v2, s[32:35], s73 offen sc1
    buffer_load_dwordx4 v[156:159], v8, s[32:35], s73 offen sc1
    s_add_u32 s46, s46, 4096
    s_cmp_eq_u32 s46, s93
    s_cselect_b32 s46, s92, s46
    s_waitcnt vmcnt(63)
    ds_read_b64_tr_b16 a[200:201], v5 offset:16384
    ds_read_b64_tr_b16 a[202:203], v5 offset:16896
    ds_read_b64_tr_b16 a[204:205], v6 offset:16384
    ds_read_b64_tr_b16 a[206:207], v6 offset:16896
    s_waitcnt vmcnt(15) lgkmcnt(4)
    v_mfma_f32_32x32x16_bf16 v[32:47], a[192:195], v[160:163], v[32:47]
    v_mfma_f32_32x32x16_bf16 v[48:63], a[192:195], v[164:167], v[48:63]
    v_mfma_f32_32x32x16_bf16 v[64:79], a[196:199], v[160:163], v[64:79]
    v_mfma_f32_32x32x16_bf16 v[80:95], a[196:199], v[164:167], v[80:95]
    s_cmp_eq_u32 s46, s64
    s_cselect_b32 s73, s65, s46
    buffer_load_dwordx4 v[160:163], v2, s[32:35], s73 offen sc1
    buffer_load_dwordx4 v[164:167], v8, s[32:35], s73 offen sc1
    s_add_u32 s46, s46, 4096
    s_cmp_eq_u32 s46, s93
    s_cselect_b32 s46, s92, s46
    s_waitcnt vmcnt(63)
    ds_read_b64_tr_b16 a[192:193], v5 offset:24576
    ds_read_b64_tr_b16 a[194:195], v5 offset:25088
    ds_read_b64_tr_b16 a[196:197], v6 offset:24576
    ds_read_b64_tr_b16 a[198:199], v6 offset:25088
    s_waitcnt vmcnt(15) lgkmcnt(4)
    v_mfma_f32_32x32x16_bf16 v[32:47], a[200:203], v[168:171], v[32:47]
    v_mfma_f32_32x32x16_bf16 v[48:63], a[200:203], v[172:175], v[48:63]
    v_mfma_f32_32x32x16_bf16 v[64:79], a[204:207], v[168:171], v[64:79]
    v_mfma_f32_32x32x16_bf16 v[80:95], a[204:207], v[172:175], v[80:95]
    s_cmp_eq_u32 s46, s64
    s_cselect_b32 s73, s65, s46
    buffer_load_dwordx4 v[168:171], v2, s[32:35], s73 offen sc1
    buffer_load_dwordx4 v[172:175], v8, s[32:35], s73 offen sc1
    s_add_u32 s46, s46, 4096
    s_cmp_eq_u32 s46, s93
    s_cselect_b32 s46, s92, s46
    s_waitcnt vmcnt(10)
    s_mov_b32 s94, 0
L_po_loop:
    v_cmp_ne_u32 vcc, s71, v29
    s_nop 4
    s_cmp_eq_u64 vcc, 0
    s_cbranch_scc1 L_po_done
    buffer_load_dword v29, v28, s[32:35], s41 offen sc1
    s_add_u32 s94, s94, 1
    s_waitcnt vmcnt(0)
    s_cmp_lt_u32 s94, 200000
    s_cbranch_scc1 L_po_loop
L_po_done:
    s_waitcnt vmcnt(63)
    ds_read_b64_tr_b16 a[200:201], v5 offset:32768
    ds_read_b64_tr_b16 a[202:203], v5 offset:33280
    ds_read_b64_tr_b16 a[204:205], v6 offset:32768
    ds_read_b64_tr_b16 a[206:207], v6 offset:33280
    s_waitcnt vmcnt(15) lgkmcnt(4)
    v_mfma_f32_32x32x16_bf16 v[32:47], a[192:195], v[176:179], v[32:47]
    v_mfma_f32_32x32x16_bf16 v[48:63], a[192:195], v[180:183], v[48:63]
    v_mfma_f32_32x32x16_bf16 v[64:79], a[196:199], v[176:179], v[64:79]
    v_mfma_f32_32x32x16_bf16 v[80:95], a[196:199], v[180:183], v[80:95]
    buffer_load_dwordx4 v[176:179], v2, s[32:35], s47 offen sc1
    buffer_load_dwordx4 v[180:183], v8, s[32:35], s47 offen sc1
    s_add_u32 s47, s47, 4096
    s_add_u32 s72, s92, 120832
    s_cmp_eq_u32 s47, s72
    s_cselect_b32 s72, 32768, 0
    s_sub_u32 s47, s47, s72
    s_waitcnt vmcnt(63)
    ds_read_b64_tr_b16 a[192:193], v5 offset:40960
    ds_read_b64_tr_b16 a[194:195], v5 offset:41472
    ds_read_b64_tr_b16 a[196:197], v6 offset:40960
    ds_read_b64_tr_b16 a[198:199], v6 offset:41472
    s_waitcnt vmcnt(15) lgkmcnt(4)
    v_mfma_f32_32x32x16_bf16 v[32:47], a[200:203], v[184:187], v[32:47]
    v_mfma_f32_32x32x16_bf16 v[48:63], a[200:203], v[188:191], v[48:63]
    v_mfma_f32_32x32x16_bf16 v[64:79], a[204:207], v[184:187], v[64:79]
    v_mfma_f32_32x32x16_bf16 v[80:95], a[204:207], v[188:191], v[80:95]
    buffer_load_dwordx4 v[184:187], v2, s[32:35], s47 offen sc1
    buffer_load_dwordx4 v[188:191], v8, s[32:35], s47 offen sc1
    s_add_u32 s47, s47, 4096
    s_add_u32 s72, s92, 120832
    s_cmp_eq_u32 s47, s72
    s_cselect_b32 s72, 32768, 0
    s_sub_u32 s47, s47, s72
    s_waitcnt vmcnt(63)
    ds_read_b64_tr_b16 a[200:201], v5 offset:49152
    ds_read_b64_tr_b16 a[202:203], v5 offset:49664
    ds_read_b64_tr_b16 a[204:205], v6 offset:49152
    ds_read_b64_tr_b16 a[206:207], v6 offset:49664
    s_waitcnt vmcnt(15) lgkmcnt(4)
    v_mfma_f32_32x32x16_bf16 v[32:47], a[192:195], v[128:131], v[32:47]
    v_mfma_f32_32x32x16_bf16 v[48:63], a[192:195], v[132:135], v[48:63]
    v_mfma_f32_32x32x16_bf16 v[64:79], a[196:199], v[128:131], v[64:79]
    v_mfma_f32_32x32x16_bf16 v[80:95], a[196:199], v[132:135], v[80:95]
    buffer_load_dwordx4 v[128:131], v2, s[32:35], s47 offen sc1
    buffer_load_dwordx4 v[132:135], v8, s[32:35], s47 offen sc1
    s_add_u32 s47, s47, 4096
    s_add_u32 s72, s92, 120832
    s_cmp_eq_u32 s47, s72
    s_cselect_b32 s72, 32768, 0
    s_sub_u32 s47, s47, s72
    s_waitcnt vmcnt(63)
    ds_read_b64_tr_b16 a[192:193], v5 offset:57344
    ds_read_b64_tr_b16 a[194:195], v5 offset:57856
    ds_read_b64_tr_b16 a[196:197], v6 offset:57344
    ds_read_b64_tr_b16 a[198:199], v6 offset:57856
    s_waitcnt vmcnt(14) lgkmcnt(4)
    v_mfma_f32_32x32x16_bf16 v[32:47], a[200:203], v[136:139], v[32:47]
    v_mfma_f32_32x32x16_bf16 v[48:63], a[200:203], v[140:143], v[48:63]
    v_mfma_f32_32x32x16_bf16 v[64:79], a[204:207], v[136:139], v[64:79]
    v_mfma_f32_32x32x16_bf16 v[80:95], a[204:207], v[140:143], v[80:95]
    buffer_load_dwordx4 v[136:139], v2, s[32:35], s47 offen sc1
    buffer_load_dwordx4 v[140:143], v8, s[32:35], s47 offen sc1
    s_add_u32 s47, s47, 4096
    s_add_u32 s72, s92, 120832
    s_cmp_eq_u32 s47, s72
    s_cselect_b32 s72, 32768, 0
    s_sub_u32 s47, s47, s72
    s_waitcnt vmcnt(63)
    ds_read_b64_tr_b16 a[200:201], v3 offset:0
    ds_read_b64_tr_b16 a[202:203], v3 offset:512
    ds_read_b64_tr_b16 a[204:205], v4 offset:0
    ds_read_b64_tr_b16 a[206:207], v4 offset:512
    s_waitcnt vmcnt(14) lgkmcnt(4)
    v_mfma_f32_32x32x16_bf16 v[32:47], a[192:195], v[144:147], v[32:47]
    v_mfma_f32_32x32x16_bf16 v[48:63], a[192:195], v[148:151], v[48:63]
    v_mfma_f32_32x32x16_bf16 v[64:79], a[196:199], v[144:147], v[64:79]
    v_mfma_f32_32x32x16_bf16 v[80:95], a[196:199], v[148:151], v[80:95]
    buffer_load_dwordx4 v[144:147], v2, s[32:35], s47 offen sc1
    buffer_load_dwordx4 v[148:151], v8, s[32:35], s47 offen sc1
    s_add_u32 s47, s47, 4096
    s_add_u32 s72, s92, 120832
    s_cmp_eq_u32 s47, s72
    s_cselect_b32 s72, 32768, 0
    s_sub_u32 s47, s47, s72
    s_waitcnt vmcnt(63)
    ds_read_b64_tr_b16 a[192:193], v3 offset:2048
    ds_read_b64_tr_b16 a[194:195], v3 offset:2560
    ds_read_b64_tr_b16 a[196:197], v4 offset:2048
    ds_read_b64_tr_b16 a[198:199], v4 offset:2560
    s_waitcnt vmcnt(14) lgkmcnt(4)
    v_mfma_f32_32x32x16_bf16 v[32:47], a[200:203], v[152:155], v[32:47]
    v_mfma_f32_32x32x16_bf16 v[48:63], a[200:203], v[156:159], v[48:63]
    v_mfma_f32_32x32x16_bf16 v[64:79], a[204:207], v[152:155], v[64:79]
    v_mfma_f32_32x32x16_bf16 v[80:95], a[204:207], v[156:159], v[80:95]
    buffer_load_dwordx4 v[152:155], v2, s[32:35], s47 offen sc1
    buffer_load_dwordx4 v[156:159], v8, s[32:35], s47 offen sc1
    s_add_u32 s47, s47, 4096
    s_add_u32 s72, s92, 120832
    s_cmp_eq_u32 s47, s72
    s_cselect_b32 s72, 32768, 0
    s_sub_u32 s47, s47, s72
    s_barrier
    s_waitcnt vmcnt(63)
    ds_read_b64_tr_b16 a[200:201], v3 offset:4096
    ds_read_b64_tr_b16 a[202:203], v3 offset:4608
    ds_read_b64_tr_b16 a[204:205], v4 offset:4096
    ds_read_b64_tr_b16 a[206:207], v4 offset:4608
    s_waitcnt vmcnt(14) lgkmcnt(4)
    v_mfma_f32_32x32x16_bf16 v[32:47], a[192:195], v[160:163], v[32:47]
    v_mfma_f32_32x32x16_bf16 v[48:63], a[192:195], v[164:167], v[48:63]
    v_mfma_f32_32x32x16_bf16 v[64:79], a[196:199], v[160:163], v[64:79]
    v_mfma_f32_32x32x16_bf16 v[80:95], a[196:199], v[164:167], v[80:95]
    buffer_load_dwordx4 v[160:163], v2, s[32:35], s47 offen sc1
    buffer_load_dwordx4 v[164:167], v8, s[32:35], s47 offen sc1
    s_add_u32 s47, s47, 4096
    s_add_u32 s72, s92, 120832
    s_cmp_eq_u32 s47, s72
    s_cselect_b32 s72, 32768, 0
    s_sub_u32 s47, s47, s72
    s_waitcnt vmcnt(63)
    ds_read_b64_tr_b16 a[192:193], v3 offset:6144
    ds_read_b64_tr_b16 a[194:195], v3 offset:6656
    ds_read_b64_tr_b16 a[196:197], v4 offset:6144
    ds_read_b64_tr_b16 a[198:199], v4 offset:6656
    s_waitcnt vmcnt(14) lgkmcnt(4)
    v_mfma_f32_32x32x16_bf16 v[32:47], a[200:203], v[168:171], v[32:47]
    v_mfma_f32_32x32x16_bf16 v[48:63], a[200:203], v[172:175], v[48:63]
    v_mfma_f32_32x32x16_bf16 v[64:79], a[204:207], v[168:171], v[64:79]
    v_mfma_f32_32x32x16_bf16 v[80:95], a[204:207], v[172:175], v[80:95]
    buffer_load_dwordx4 v[168:171], v2, s[32:35], s47 offen sc1
    buffer_load_dwordx4 v[172:175], v8, s[32:35], s47 offen sc1
    s_add_u32 s47, s47, 4096
    s_add_u32 s72, s92, 120832
    s_cmp_eq_u32 s47, s72
    s_cselect_b32 s72, 32768, 0
    s_sub_u32 s47, s47, s72
    s_waitcnt vmcnt(63)
    ds_read_b64_tr_b16 a[200:201], v3 offset:8192
    ds_read_b64_tr_b16 a[202:203], v3 offset:8704
    ds_read_b64_tr_b16 a[204:205], v4 offset:8192
    ds_read_b64_tr_b16 a[206:207], v4 offset:8704
    s_waitcnt vmcnt(14) lgkmcnt(4)
    v_mfma_f32_32x32x16_bf16 v[32:47], a[192:195], v[176:179], v[32:47]
    v_mfma_f32_32x32x16_bf16 v[48:63], a[192:195], v[180:183], v[48:63]
    v_mfma_f32_32x32x16_bf16 v[64:79], a[196:199], v[176:179], v[64:79]
    v_mfma_f32_32x32x16_bf16 v[80:95], a[196:199], v[180:183], v[80:95]
    s_waitcnt vmcnt(63)
    ds_read_b64_tr_b16 a[192:193], v3 offset:10240
    ds_read_b64_tr_b16 a[194:195], v3 offset:10752
    ds_read_b64_tr_b16 a[196:197], v4 offset:10240
    ds_read_b64_tr_b16 a[198:199], v4 offset:10752
    s_waitcnt vmcnt(12) lgkmcnt(4)
    v_mfma_f32_32x32x16_bf16 v[32:47], a[200:203], v[184:187], v[32:47]
    v_mfma_f32_32x32x16_bf16 v[48:63], a[200:203], v[188:191], v[48:63]
    v_mfma_f32_32x32x16_bf16 v[64:79], a[204:207], v[184:187], v[64:79]
    v_mfma_f32_32x32x16_bf16 v[80:95], a[204:207], v[188:191], v[80:95]
    s_waitcnt vmcnt(63)
    ds_read_b64_tr_b16 a[200:201], v3 offset:12288
    ds_read_b64_tr_b16 a[202:203], v3 offset:12800
    ds_read_b64_tr_b16 a[204:205], v4 offset:12288
    ds_read_b64_tr_b16 a[206:207], v4 offset:12800
    s_waitcnt vmcnt(10) lgkmcnt(4)
    v_mfma_f32_32x32x16_bf16 v[32:47], a[192:195], v[128:131], v[32:47]
    v_mfma_f32_32x32x16_bf16 v[48:63], a[192:195], v[132:135], v[48:63]
    v_mfma_f32_32x32x16_bf16 v[64:79], a[196:199], v[128:131], v[64:79]
    v_mfma_f32_32x32x16_bf16 v[80:95], a[196:199], v[132:135], v[80:95]
    s_waitcnt vmcnt(63)
    ds_read_b64_tr_b16 a[192:193], v3 offset:14336
    ds_read_b64_tr_b16 a[194:195], v3 offset:14848
    ds_read_b64_tr_b16 a[196:197], v4 offset:14336
    ds_read_b64_tr_b16 a[198:199], v4 offset:14848
    s_waitcnt vmcnt(8) lgkmcnt(4)
    v_mfma_f32_32x32x16_bf16 v[32:47], a[200:203], v[136:139], v[32:47]
    v_mfma_f32_32x32x16_bf16 v[48:63], a[200:203], v[140:143], v[48:63]
    v_mfma_f32_32x32x16_bf16 v[64:79], a[204:207], v[136:139], v[64:79]
    v_mfma_f32_32x32x16_bf16 v[80:95], a[204:207], v[140:143], v[80:95]
    s_waitcnt vmcnt(63)
    ds_read_b64_tr_b16 a[200:201], v3 offset:16384
    ds_read_b64_tr_b16 a[202:203], v3 offset:16896
    ds_read_b64_tr_b16 a[204:205], v4 offset:16384
    ds_read_b64_tr_b16 a[206:207], v4 offset:16896
    s_waitcnt vmcnt(6) lgkmcnt(4)
    v_mfma_f32_32x32x16_bf16 v[32:47], a[192:195], v[144:147], v[32:47]
    v_mfma_f32_32x32x16_bf16 v[48:63], a[192:195], v[148:151], v[48:63]
    v_mfma_f32_32x32x16_bf16 v[64:79], a[196:199], v[144:147], v[64:79]
    v_mfma_f32_32x32x16_bf16 v[80:95], a[196:199], v[148:151], v[80:95]
    s_waitcnt vmcnt(63)
    ds_read_b64_tr_b16 a[192:193], v3 offset:18432
    ds_read_b64_tr_b16 a[194:195], v3 offset:18944
    ds_read_b64_tr_b16 a[196:197], v4 offset:18432
    ds_read_b64_tr_b16 a[198:199], v4 offset:18944
    s_waitcnt vmcnt(4) lgkmcnt(4)
    v_mfma_f32_32x32x16_bf16 v[32:47], a[200:203], v[152:155], v[32:47]
    v_mfma_f32_32x32x16_bf16 v[48:63], a[200:203], v[156:159], v[48:63]
    v_mfma_f32_32x32x16_bf16 v[64:79], a[204:207], v[152:155], v[64:79]
    v_mfma_f32_32x32x16_bf16 v[80:95], a[204:207], v[156:159], v[80:95]
    s_waitcnt vmcnt(63)
    ds_read_b64_tr_b16 a[200:201], v3 offset:20480
    ds_read_b64_tr_b16 a[202:203], v3 offset:20992
    ds_read_b64_tr_b16 a[204:205], v4 offset:20480
    ds_read_b64_tr_b16 a[206:207], v4 offset:20992
    s_waitcnt vmcnt(2) lgkmcnt(4)
    v_mfma_f32_32x32x16_bf16 v[32:47], a[192:195], v[160:163], v[32:47]
    v_mfma_f32_32x32x16_bf16 v[48:63], a[192:195], v[164:167], v[48:63]
    v_mfma_f32_32x32x16_bf16 v[64:79], a[196:199], v[160:163], v[64:79]
    v_mfma_f32_32x32x16_bf16 v[80:95], a[196:199], v[164:167], v[80:95]
    s_waitcnt vmcnt(0) lgkmcnt(0)
    v_mfma_f32_32x32x16_bf16 v[32:47], a[200:203], v[168:171], v[32:47]
    v_mfma_f32_32x32x16_bf16 v[48:63], a[200:203], v[172:175], v[48:63]
    v_mfma_f32_32x32x16_bf16 v[64:79], a[204:207], v[168:171], v[64:79]
    v_mfma_f32_32x32x16_bf16 v[80:95], a[204:207], v[172:175], v[80:95]
    v_mov_b32 v19, v2
    s_cmp_eq_u32 s68, 0
    s_cbranch_scc1 L_rs0
    s_cmp_eq_u32 s68, 1
    s_cbranch_scc1 L_rs1
    s_cmp_eq_u32 s68, 2
    s_cbranch_scc1 L_rs2
L_rs3:
    v_add_u32 v18, 98304, v2
    s_nop 9
    ds_write_b128 v18, v[32:35] offset:0
    ds_write_b128 v18, v[36:39] offset:1024
    ds_write_b128 v18, v[40:43] offset:2048
    ds_write_b128 v18, v[44:47] offset:3072
    ds_write_b128 v18, v[48:51] offset:20480
    ds_write_b128 v18, v[52:55] offset:21504
    ds_write_b128 v18, v[56:59] offset:22528
    ds_write_b128 v18, v[60:63] offset:23552
    ds_write_b128 v18, v[64:67] offset:40960
    ds_write_b128 v18, v[68:71] offset:41984
    ds_write_b128 v18, v[72:75] offset:43008
    ds_write_b128 v18, v[76:79] offset:44032
    v_mov_b32 v96, v80
    v_mov_b32 v97, v81
    v_mov_b32 v98, v82
    v_mov_b32 v99, v83
    v_mov_b32 v100, v84
    v_mov_b32 v101, v85
    v_mov_b32 v102, v86
    v_mov_b32 v103, v87
    v_mov_b32 v104, v88
    v_mov_b32 v105, v89
    v_mov_b32 v106, v90
    v_mov_b32 v107, v91
    v_mov_b32 v108, v92
    v_mov_b32 v109, v93
    v_mov_b32 v110, v94
    v_mov_b32 v111, v95
    s_branch L_rsj
L_rs0:
    v_add_u32 v18, 98304, v2
    s_nop 9
    ds_write_b128 v18, v[48:51] offset:16384
    ds_write_b128 v18, v[52:55] offset:17408
    ds_write_b128 v18, v[56:59] offset:18432
    ds_write_b128 v18, v[60:63] offset:19456
    ds_write_b128 v18, v[64:67] offset:36864
    ds_write_b128 v18, v[68:71] offset:37888
    ds_write_b128 v18, v[72:75] offset:38912
    ds_write_b128 v18, v[76:79] offset:39936
    ds_write_b128 v18, v[80:83] offset:57344
    ds_write_b128 v18, v[84:87] offset:58368
    ds_write_b128 v18, v[88:91] offset:59392
    ds_write_b128 v18, v[92:95] offset:60416
    v_mov_b32 v96, v32
    v_mov_b32 v97, v33
    v_mov_b32 v98, v34
    v_mov_b32 v99, v35
    v_mov_b32 v100, v36
    v_mov_b32 v101, v37
    v_mov_b32 v102, v38
    v_mov_b32 v103, v39
    v_mov_b32 v104, v40
    v_mov_b32 v105, v41
    v_mov_b32 v106, v42
    v_mov_b32 v107, v43
    v_mov_b32 v108, v44
    v_mov_b32 v109, v45
    v_mov_b32 v110, v46
    v_mov_b32 v111, v47
    s_branch L_rsj
L_rs1:
    v_add_u32 v18, 98304, v2
    s_nop 9
    ds_write_b128 v18, v[64:67] offset:32768
    ds_write_b128 v18, v[68:71] offset:33792
    ds_write_b128 v18, v[72:75] offset:34816
    ds_write_b128 v18, v[76:79] offset:35840
    ds_write_b128 v18, v[80:83] offset:53248
    ds_write_b128 v18, v[84:87] offset:54272
    ds_write_b128 v18, v[88:91] offset:55296
    ds_write_b128 v18, v[92:95] offset:56320
    ds_write_b128 v18, v[32:35] offset:8192
    ds_write_b128 v18, v[36:39] offset:9216
    ds_write_b128 v18, v[40:43] offset:10240
    ds_write_b128 v18, v[44:47] offset:11264
    v_mov_b32 v96, v48
    v_mov_b32 v97, v49
    v_mov_b32 v98, v50
    v_mov_b32 v99, v51
    v_mov_b32 v100, v52
    v_mov_b32 v101, v53
    v_mov_b32 v102, v54
    v_mov_b32 v103, v55
    v_mov_b32 v104, v56
    v_mov_b32 v105, v57
    v_mov_b32 v106, v58
    v_mov_b32 v107, v59
    v_mov_b32 v108, v60
    v_mov_b32 v109, v61
    v_mov_b32 v110, v62
    v_mov_b32 v111, v63
    s_branch L_rsj
L_rs2:
    v_add_u32 v18, 98304, v2
    s_nop 9
    ds_write_b128 v18, v[80:83] offset:49152
    ds_write_b128 v18, v[84:87] offset:50176
    ds_write_b128 v18, v[88:91] offset:51200
    ds_write_b128 v18, v[92:95] offset:52224
    ds_write_b128 v18, v[32:35] offset:4096
    ds_write_b128 v18, v[36:39] offset:5120
    ds_write_b128 v18, v[40:43] offset:6144
    ds_write_b128 v18, v[44:47] offset:7168
    ds_write_b128 v18, v[48:51] offset:24576
    ds_write_b128 v18, v[52:55] offset:25600
    ds_write_b128 v18, v[56:59] offset:26624
    ds_write_b128 v18, v[60:63] offset:27648
    v_mov_b32 v96, v64
    v_mov_b32 v97, v65
    v_mov_b32 v98, v66
    v_mov_b32 v99, v67
    v_mov_b32 v100, v68
    v_mov_b32 v101, v69
    v_mov_b32 v102, v70
    v_mov_b32 v103, v71
    v_mov_b32 v104, v72
    v_mov_b32 v105, v73
    v_mov_b32 v106, v74
    v_mov_b32 v107, v75
    v_mov_b32 v108, v76
    v_mov_b32 v109, v77
    v_mov_b32 v110, v78
    v_mov_b32 v111, v79
L_rsj:
    s_waitcnt lgkmcnt(0)
    s_barrier
    s_lshl_b32 s72, s68, 14
    s_add_u32 s72, s72, 98304
    v_add_u32 v18, s72, v2
    ds_read_b128 v[112:115], v18 offset:0
    ds_read_b128 v[116:119], v18 offset:1024
    ds_read_b128 v[120:123], v18 offset:2048
    ds_read_b128 v[124:127], v18 offset:3072
    ds_read_b128 v[128:131], v18 offset:4096
    ds_read_b128 v[132:135], v18 offset:5120
    ds_read_b128 v[136:139], v18 offset:6144
    ds_read_b128 v[140:143], v18 offset:7168
    ds_read_b128 v[144:147], v18 offset:8192
    ds_read_b128 v[148:151], v18 offset:9216
    ds_read_b128 v[152:155], v18 offset:10240
    ds_read_b128 v[156:159], v18 offset:11264
    s_waitcnt lgkmcnt(8)
    v_pk_add_f32 v[96:97], v[96:97], v[112:113]
    v_pk_add_f32 v[98:99], v[98:99], v[114:115]
    v_pk_add_f32 v[100:101], v[100:101], v[116:117]
    v_pk_add_f32 v[102:103], v[102:103], v[118:119]
    v_pk_add_f32 v[104:105], v[104:105], v[120:121]
    v_pk_add_f32 v[106:107], v[106:107], v[122:123]
    v_pk_add_f32 v[108:109], v[108:109], v[124:125]
    v_pk_add_f32 v[110:111], v[110:111], v[126:127]
    s_waitcnt lgkmcnt(0)
    v_pk_add_f32 v[128:129], v[128:129], v[144:145]
    v_pk_add_f32 v[130:131], v[130:131], v[146:147]
    v_pk_add_f32 v[132:133], v[132:133], v[148:149]
    v_pk_add_f32 v[134:135], v[134:135], v[150:151]
    v_pk_add_f32 v[136:137], v[136:137], v[152:153]
    v_pk_add_f32 v[138:139], v[138:139], v[154:155]
    v_pk_add_f32 v[140:141], v[140:141], v[156:157]
    v_pk_add_f32 v[142:143], v[142:143], v[158:159]
    v_pk_add_f32 v[96:97], v[96:97], v[128:129]
    v_pk_add_f32 v[98:99], v[98:99], v[130:131]
    v_pk_add_f32 v[100:101], v[100:101], v[132:133]
    v_pk_add_f32 v[102:103], v[102:103], v[134:135]
    v_pk_add_f32 v[104:105], v[104:105], v[136:137]
    v_pk_add_f32 v[106:107], v[106:107], v[138:139]
    v_pk_add_f32 v[108:109], v[108:109], v[140:141]
    v_pk_add_f32 v[110:111], v[110:111], v[142:143]
    v_permlane32_swap_b32 v96, v100
    v_permlane32_swap_b32 v97, v101
    v_permlane32_swap_b32 v98, v102
    v_permlane32_swap_b32 v99, v103
    v_permlane32_swap_b32 v104, v108
    v_permlane32_swap_b32 v105, v109
    v_permlane32_swap_b32 v106, v110
    v_permlane32_swap_b32 v107, v111
    s_waitcnt vmcnt(45)
    v_lshlrev_b32 v20, 16, v232
    v_and_b32 v21, 0xffff0000, v232
    v_pk_add_f32 v[96:97], v[96:97], v[20:21]
    v_cvt_pk_bf16_f32 v112, v96, v97
    v_lshlrev_b32 v20, 16, v233
    v_and_b32 v21, 0xffff0000, v233
    v_pk_add_f32 v[98:99], v[98:99], v[20:21]
    v_cvt_pk_bf16_f32 v113, v98, v99
    v_lshlrev_b32 v20, 16, v234
    v_and_b32 v21, 0xffff0000, v234
    v_pk_add_f32 v[100:101], v[100:101], v[20:21]
    v_cvt_pk_bf16_f32 v114, v100, v101
    v_lshlrev_b32 v20, 16, v235
    v_and_b32 v21, 0xffff0000, v235
    v_pk_add_f32 v[102:103], v[102:103], v[20:21]
    v_cvt_pk_bf16_f32 v115, v102, v103
    v_lshlrev_b32 v20, 16, v236
    v_and_b32 v21, 0xffff0000, v236
    v_pk_add_f32 v[104:105], v[104:105], v[20:21]
    v_cvt_pk_bf16_f32 v116, v104, v105
    v_lshlrev_b32 v20, 16, v237
    v_and_b32 v21, 0xffff0000, v237
    v_pk_add_f32 v[106:107], v[106:107], v[20:21]
    v_cvt_pk_bf16_f32 v117, v106, v107
    v_lshlrev_b32 v20, 16, v238
    v_and_b32 v21, 0xffff0000, v238
    v_pk_add_f32 v[108:109], v[108:109], v[20:21]
    v_cvt_pk_bf16_f32 v118, v108, v109
    v_lshlrev_b32 v20, 16, v239
    v_and_b32 v21, 0xffff0000, v239
    v_pk_add_f32 v[110:111], v[110:111], v[20:21]
    v_cvt_pk_bf16_f32 v119, v110, v111
    buffer_store_dwordx4 v[112:115], v7, s[28:31], 0 offen
    buffer_store_dwordx4 v[116:119], v7, s[28:31], 0 offen offset:32
    s_cmp_lg_u32 s2, 0
    s_cbranch_scc1 L_end
    s_cmp_lg_u32 s68, 0
    s_cbranch_scc1 L_end
    v_mov_b32 v18, s71
    s_mov_b64 exec, 1
    buffer_store_dword v18, off, s[32:35], 0 sc1
L_end:
    s_endpgm
.section .rodata,"a"
.p2align 6
.amdhsa_kernel parallel_sum__linear_kernel_hedgehog__glu_gated_reglu__prompt_kernel
  .amdhsa_next_free_vgpr 512
  .amdhsa_next_free_sgpr 102
  .amdhsa_accum_offset 256
  .amdhsa_group_segment_fixed_size 0
  .amdhsa_kernarg_size 88
  .amdhsa_user_sgpr_count 2
  .amdhsa_user_sgpr_kernarg_segment_ptr 1
  .amdhsa_system_sgpr_workgroup_id_x 1
.end_amdhsa_kernel
```
